```python
import torch

def _softmax(x, axis=-1):
    return torch.softmax(x, dim=axis)
def _gelu(x):
    return torch.nn.functional.gelu(x, approximate="tanh")
def _silu(x):
    return torch.nn.functional.silu(x)
def _sigmoid(x):
    return torch.sigmoid(x)
def _layernorm(x, axis=-1, eps=1e-5):
    m = x.mean(dim=axis, keepdim=True)
    v = x.var(dim=axis, keepdim=True, unbiased=False)
    return (x - m) / torch.sqrt(v + eps)
def _scatter_add(tgt, idx, src, axis=0):
    return tgt.clone().index_add_(axis, idx, src)
def _segment_sum(src, seg, n):
    out = torch.zeros((n,) + src.shape[1:], dtype=src.dtype)
    return out.index_add_(0, seg, src)
def _pad(x, pw):
    flat = tuple(v for pair in reversed(pw) for v in pair)
    return torch.nn.functional.pad(x, flat)

kernel_name = 'concat_heads__spectral_fnet__sliding_local_dilated__prompt'

def setup_inputs():

    _w = (lambda a: (lambda t: t.to(torch.bfloat16) if t.is_floating_point() else t)(torch.as_tensor(a)))
    def _A_setup():
        B, S, D = 1, 2048, 640
        ns = torch.arange(S)[:, None] * torch.arange(S)[None, :]
        nd = torch.arange(D)[:, None] * torch.arange(D)[None, :]
        Ws_re = torch.cos(-2.0 * torch.pi * ns / S).to(float)
        Ws_im = torch.sin(-2.0 * torch.pi * ns / S).to(float)
        Wd_re = torch.cos(-2.0 * torch.pi * nd / D).to(float)
        Wd_im = torch.sin(-2.0 * torch.pi * nd / D).to(float)
        return {
            "x": _w((lambda *s: torch.randn(*s, dtype=torch.bfloat16) * 0.05)(B, S, D)),
            "dft_seq_re": _w(Ws_re),
            "dft_seq_im": _w(Ws_im),
            "dft_hid_re": _w(Wd_re),
            "dft_hid_im": _w(Wd_im),
        }
    _A_in = _A_setup()

    def _B_setup():
        B, S, D = 1, 2048, 640
        return {
            "x": _w((lambda *s: torch.randn(*s, dtype=torch.bfloat16) * 0.2)(B, S, D)),
            "wqkv": _w((lambda *s: torch.randn(*s, dtype=torch.bfloat16) * 0.8)(D, 3 * D)),
            "wo": _w((lambda *s: torch.randn(*s, dtype=torch.bfloat16) * 0.2)(D, D)),
        }
    _B_in = _B_setup()

    return {
        "A_x": _A_in["x"],
        "A_dft_seq_re": _A_in["dft_seq_re"],
        "A_dft_seq_im": _A_in["dft_seq_im"],
        "A_dft_hid_re": _A_in["dft_hid_re"],
        "A_dft_hid_im": _A_in["dft_hid_im"],
        "B_x": _B_in["x"],
        "B_wqkv": _B_in["wqkv"],
        "B_wo": _B_in["wo"],
    }

def reference(A_x, A_dft_seq_re, A_dft_seq_im, A_dft_hid_re, A_dft_hid_im, B_x, B_wqkv, B_wo):
    def _A_ref(x, dft_seq_re, dft_seq_im, dft_hid_re, dft_hid_im):
        a = torch.einsum("bsd,ed->bse", x, dft_hid_re)
        b = torch.einsum("bsd,ed->bse", x, dft_hid_im)
        y = torch.einsum("ts,bse->bte", dft_seq_re, a) - torch.einsum("ts,bse->bte", dft_seq_im, b)
        return y

    def _B_ref(x, wqkv, wo):
        B, S, D = x.shape
        H = 32; Dh = D // H
        W, dil = 8, 2
        qkv = (lambda x, *d: x.permute(*d))((x @ wqkv).reshape(B, S, 3, H, Dh), 2, 0, 3, 1, 4)
        q, k, v = qkv[0], qkv[1], qkv[2]
        scale = Dh ** -0.5
        pos = torch.arange(S)
        off = torch.arange(W) * dil
        idx = pos[:, None] - off[None, :]
        mask = idx >= 0
        idx_c = torch.where(mask, idx, 0).reshape(-1)
        kg = k[:, :, idx_c, :].reshape(B, H, S, W, Dh)
        vg = v[:, :, idx_c, :].reshape(B, H, S, W, Dh)
        logits = torch.einsum("bhsd,bhswd->bhsw", q, kg) * scale
        logits = torch.where(mask[None, None, :, :], logits, -1e9)
        attn = _softmax(logits, axis=-1)
        o = torch.einsum("bhsw,bhswd->bhsd", attn, vg)
        return (lambda x, *d: x.permute(*d))(o, 0, 2, 1, 3).reshape(B, S, D) @ wo

    a = _A_ref(A_x, A_dft_seq_re, A_dft_seq_im, A_dft_hid_re, A_dft_hid_im)
    b = _B_ref(B_x, B_wqkv, B_wo)
    return torch.concatenate([a, b], axis=-1)
```

```asm
; @launch grid=(256,1,1) block=(512,1,1) lds=163840
.amdgcn_target "amdgcn-amd-amdhsa--gfx950"
.text
.globl concat_heads__spectral_fnet__sliding_local_dilated__prompt_kernel
.p2align 8
.type concat_heads__spectral_fnet__sliding_local_dilated__prompt_kernel,@function
concat_heads__spectral_fnet__sliding_local_dilated__prompt_kernel:
    s_cmp_ge_u32 s2, 256
    s_cbranch_scc1 K_END
    s_load_dwordx16 s[60:75], s[0:1], 0
    s_load_dwordx4 s[76:79], s[0:1], 64
    s_load_dwordx2 s[80:81], s[0:1], 80
    v_lshrrev_b32 v1, 6, v0
    v_and_b32 v0, 63, v0
    s_and_b32 s58, s2, 7
    s_lshr_b32 s59, s2, 3
    v_readfirstlane_b32 s16, v1
    s_cmp_ge_u32 s59, 24
    s_cbranch_scc1 A1
    s_lshr_b32 s17, s58, 2
    s_and_b32 s46, s58, 3
    s_lshl_b32 s46, s46, 8
    s_lshr_b32 s45, s59, 3
    s_and_b32 s18, s59, 7
    s_mul_i32 s39, s45, 88
    s_add_u32 s42, s39, 88
    s_min_u32 s42, s42, 256
    s_add_u32 s39, s39, s46
    s_add_u32 s42, s42, s46
    s_max_u32 s19, s39, 8
    s_sub_u32 s19, s19, 8
    v_mov_b32 v8, 1073741824
    v_mov_b32 v255, 0
    s_cmp_lt_u32 s16, 4
    s_cbranch_scc1 B1_PROD
    s_setprio 3
    s_lshl_b32 s26, s58, 2
    s_lshr_b32 s26, 0x76543210, s26
    s_and_b32 s26, s26, 15
    s_cmp_eq_u32 s16, 4
    s_cbranch_scc1 B1_X
    s_sub_u32 s46, s16, 5
    s_mul_i32 s25, s46, 10240
    s_add_u32 s25, s25, 12288
    s_add_u32 s27, s25, 86016
    s_mul_i32 s51, s45, 3
    s_lshr_b32 s14, s45, 1
    s_add_u32 s51, s51, s14
    s_and_b32 s14, s18, 3
    s_lshl_b32 s14, s14, 2
    s_lshr_b32 s14, 0x5720, s14
    s_and_b32 s14, s14, 15
    s_add_u32 s51, s51, s14
    s_cmp_ge_u32 s51, 10
    s_cselect_b32 s14, 10, 0
    s_sub_u32 s51, s51, s14
    s_lshl_b32 s51, s51, 10
    s_movk_i32 s14, 10240
    s_mul_i32 s15, s46, 640
    s_mul_i32 s47, s18, 160
    s_movk_i32 s4, -30
    s_movk_i32 s5, 3360
    s_movk_i32 s6, 1120
    s_movk_i32 s7, 15360
    s_mov_b32 s8, -46080
    s_mov_b32 s24, 245760
    s_mul_i32 s26, s26, s24
    v_mov_b32 v20, v8
    v_mov_b32 v21, v8
    s_lshr_b32 s49, s51, 4
    s_add_u32 s49, s49, s15
    v_add_u32 v2, s49, v0
    v_mul_u32_u24 v3, 2185, v2
    v_lshrrev_b32 v3, 16, v3
    v_mad_i32_i24 v4, v3, s4, v2
    v_lshl_add_u32 v2, v2, 4, s47
    v_mul_u32_u24 v4, 26, v4
    v_lshrrev_b32 v4, 8, v4
    v_mad_u32_u24 v2, v3, s5, v2
    v_mad_u32_u24 v2, v4, s6, v2
    v_bfe_u32 v4, v3, 2, 2
    v_bfe_u32 v3, v3, 4, 1
    v_mad_u32_u24 v2, v4, s7, v2
    v_mad_i32_i24 v10, v3, s8, v2
    s_waitcnt lgkmcnt(0)
    s_mov_b32 s20, s72
    s_mov_b32 s21, s73
    s_mov_b32 s22, 2457600
    s_mov_b32 s23, 0x20000
    s_add_u32 m0, s27, s51
    s_add_u32 s51, s51, 1024
    buffer_load_dwordx4 v10, s[20:23], s26 offen lds
    s_cmp_eq_u32 s51, s14
    s_cselect_b32 s51, 0, s51
    s_lshr_b32 s49, s51, 4
    s_add_u32 s49, s49, s15
    v_add_u32 v2, s49, v0
    v_mul_u32_u24 v3, 2185, v2
    v_lshrrev_b32 v3, 16, v3
    v_mad_i32_i24 v4, v3, s4, v2
    v_lshl_add_u32 v2, v2, 4, s47
    v_mul_u32_u24 v4, 26, v4
    v_lshrrev_b32 v4, 8, v4
    v_mad_u32_u24 v2, v3, s5, v2
    v_mad_u32_u24 v2, v4, s6, v2
    v_bfe_u32 v4, v3, 2, 2
    v_bfe_u32 v3, v3, 4, 1
    v_mad_u32_u24 v2, v4, s7, v2
    v_mad_i32_i24 v11, v3, s8, v2
    s_add_u32 m0, s27, s51
    s_add_u32 s51, s51, 1024
    buffer_load_dwordx4 v11, s[20:23], s26 offen lds
    s_cmp_eq_u32 s51, s14
    s_cselect_b32 s51, 0, s51
    s_lshr_b32 s49, s51, 4
    s_add_u32 s49, s49, s15
    v_add_u32 v2, s49, v0
    v_mul_u32_u24 v3, 2185, v2
    v_lshrrev_b32 v3, 16, v3
    v_mad_i32_i24 v4, v3, s4, v2
    v_lshl_add_u32 v2, v2, 4, s47
    v_mul_u32_u24 v4, 26, v4
    v_lshrrev_b32 v4, 8, v4
    v_mad_u32_u24 v2, v3, s5, v2
    v_mad_u32_u24 v2, v4, s6, v2
    v_bfe_u32 v4, v3, 2, 2
    v_bfe_u32 v3, v3, 4, 1
    v_mad_u32_u24 v2, v4, s7, v2
    v_mad_i32_i24 v12, v3, s8, v2
    s_add_u32 m0, s27, s51
    s_add_u32 s51, s51, 1024
    buffer_load_dwordx4 v12, s[20:23], s26 offen lds
    s_cmp_eq_u32 s51, s14
    s_cselect_b32 s51, 0, s51
    s_lshr_b32 s49, s51, 4
    s_add_u32 s49, s49, s15
    v_add_u32 v2, s49, v0
    v_mul_u32_u24 v3, 2185, v2
    v_lshrrev_b32 v3, 16, v3
    v_mad_i32_i24 v4, v3, s4, v2
    v_lshl_add_u32 v2, v2, 4, s47
    v_mul_u32_u24 v4, 26, v4
    v_lshrrev_b32 v4, 8, v4
    v_mad_u32_u24 v2, v3, s5, v2
    v_mad_u32_u24 v2, v4, s6, v2
    v_bfe_u32 v4, v3, 2, 2
    v_bfe_u32 v3, v3, 4, 1
    v_mad_u32_u24 v2, v4, s7, v2
    v_mad_i32_i24 v13, v3, s8, v2
    s_add_u32 m0, s27, s51
    s_add_u32 s51, s51, 1024
    buffer_load_dwordx4 v13, s[20:23], s26 offen lds
    s_cmp_eq_u32 s51, s14
    s_cselect_b32 s51, 0, s51
    s_lshr_b32 s49, s51, 4
    s_add_u32 s49, s49, s15
    v_add_u32 v2, s49, v0
    v_mul_u32_u24 v3, 2185, v2
    v_lshrrev_b32 v3, 16, v3
    v_mad_i32_i24 v4, v3, s4, v2
    v_lshl_add_u32 v2, v2, 4, s47
    v_mul_u32_u24 v4, 26, v4
    v_lshrrev_b32 v4, 8, v4
    v_mad_u32_u24 v2, v3, s5, v2
    v_mad_u32_u24 v2, v4, s6, v2
    v_bfe_u32 v4, v3, 2, 2
    v_bfe_u32 v3, v3, 4, 1
    v_mad_u32_u24 v2, v4, s7, v2
    v_mad_i32_i24 v14, v3, s8, v2
    s_add_u32 m0, s27, s51
    s_add_u32 s51, s51, 1024
    buffer_load_dwordx4 v14, s[20:23], s26 offen lds
    s_cmp_eq_u32 s51, s14
    s_cselect_b32 s51, 0, s51
    s_lshr_b32 s49, s51, 4
    s_add_u32 s49, s49, s15
    v_add_u32 v2, s49, v0
    v_mul_u32_u24 v3, 2185, v2
    v_lshrrev_b32 v3, 16, v3
    v_mad_i32_i24 v4, v3, s4, v2
    v_lshl_add_u32 v2, v2, 4, s47
    v_mul_u32_u24 v4, 26, v4
    v_lshrrev_b32 v4, 8, v4
    v_mad_u32_u24 v2, v3, s5, v2
    v_mad_u32_u24 v2, v4, s6, v2
    v_bfe_u32 v4, v3, 2, 2
    v_bfe_u32 v3, v3, 4, 1
    v_mad_u32_u24 v2, v4, s7, v2
    v_mad_i32_i24 v15, v3, s8, v2
    s_add_u32 m0, s27, s51
    s_add_u32 s51, s51, 1024
    buffer_load_dwordx4 v15, s[20:23], s26 offen lds
    s_cmp_eq_u32 s51, s14
    s_cselect_b32 s51, 0, s51
    s_lshr_b32 s49, s51, 4
    s_add_u32 s49, s49, s15
    v_add_u32 v2, s49, v0
    v_mul_u32_u24 v3, 2185, v2
    v_lshrrev_b32 v3, 16, v3
    v_mad_i32_i24 v4, v3, s4, v2
    v_lshl_add_u32 v2, v2, 4, s47
    v_mul_u32_u24 v4, 26, v4
    v_lshrrev_b32 v4, 8, v4
    v_mad_u32_u24 v2, v3, s5, v2
    v_mad_u32_u24 v2, v4, s6, v2
    v_bfe_u32 v4, v3, 2, 2
    v_bfe_u32 v3, v3, 4, 1
    v_mad_u32_u24 v2, v4, s7, v2
    v_mad_i32_i24 v16, v3, s8, v2
    s_add_u32 m0, s27, s51
    s_add_u32 s51, s51, 1024
    buffer_load_dwordx4 v16, s[20:23], s26 offen lds
    s_cmp_eq_u32 s51, s14
    s_cselect_b32 s51, 0, s51
    s_lshr_b32 s49, s51, 4
    s_add_u32 s49, s49, s15
    v_add_u32 v2, s49, v0
    v_mul_u32_u24 v3, 2185, v2
    v_lshrrev_b32 v3, 16, v3
    v_mad_i32_i24 v4, v3, s4, v2
    v_lshl_add_u32 v2, v2, 4, s47
    v_mul_u32_u24 v4, 26, v4
    v_lshrrev_b32 v4, 8, v4
    v_mad_u32_u24 v2, v3, s5, v2
    v_mad_u32_u24 v2, v4, s6, v2
    v_bfe_u32 v4, v3, 2, 2
    v_bfe_u32 v3, v3, 4, 1
    v_mad_u32_u24 v2, v4, s7, v2
    v_mad_i32_i24 v17, v3, s8, v2
    s_add_u32 m0, s27, s51
    s_add_u32 s51, s51, 1024
    buffer_load_dwordx4 v17, s[20:23], s26 offen lds
    s_cmp_eq_u32 s51, s14
    s_cselect_b32 s51, 0, s51
    s_lshr_b32 s49, s51, 4
    s_add_u32 s49, s49, s15
    v_add_u32 v2, s49, v0
    v_mul_u32_u24 v3, 2185, v2
    v_lshrrev_b32 v3, 16, v3
    v_mad_i32_i24 v4, v3, s4, v2
    v_lshl_add_u32 v2, v2, 4, s47
    v_mul_u32_u24 v4, 26, v4
    v_lshrrev_b32 v4, 8, v4
    v_mad_u32_u24 v2, v3, s5, v2
    v_mad_u32_u24 v2, v4, s6, v2
    v_bfe_u32 v4, v3, 2, 2
    v_bfe_u32 v3, v3, 4, 1
    v_mad_u32_u24 v2, v4, s7, v2
    v_mad_i32_i24 v18, v3, s8, v2
    s_add_u32 m0, s27, s51
    s_add_u32 s51, s51, 1024
    buffer_load_dwordx4 v18, s[20:23], s26 offen lds
    s_cmp_eq_u32 s51, s14
    s_cselect_b32 s51, 0, s51
    s_lshr_b32 s49, s51, 4
    s_add_u32 s49, s49, s15
    v_add_u32 v2, s49, v0
    v_mul_u32_u24 v3, 2185, v2
    v_lshrrev_b32 v3, 16, v3
    v_mad_i32_i24 v4, v3, s4, v2
    v_lshl_add_u32 v2, v2, 4, s47
    v_mul_u32_u24 v4, 26, v4
    v_lshrrev_b32 v4, 8, v4
    v_mad_u32_u24 v2, v3, s5, v2
    v_mad_u32_u24 v2, v4, s6, v2
    v_bfe_u32 v4, v3, 2, 2
    v_bfe_u32 v3, v3, 4, 1
    v_mad_u32_u24 v2, v4, s7, v2
    v_mad_i32_i24 v19, v3, s8, v2
    s_add_u32 m0, s27, s51
    s_add_u32 s51, s51, 1024
    buffer_load_dwordx4 v19, s[20:23], s26 offen lds
    s_cmp_eq_u32 s51, s14
    s_cselect_b32 s51, 0, s51
    s_mov_b64 vcc, 0
B1_GO:
    s_mov_b32 s27, s25
    s_add_u32 s26, s26, s24
    s_mul_i32 s47, s24, 10
    s_add_u32 s48, s25, 129024
    s_mov_b32 s28, 0
B1_LLOOP:
    s_add_u32 m0, s27, s51
    s_add_u32 s51, s51, 1024
    buffer_load_dwordx4 v10, s[20:23], s26 offen lds
    s_cmp_eq_u32 s51, s14
    s_cselect_b32 s51, 0, s51
    s_add_u32 m0, s27, s51
    s_add_u32 s51, s51, 1024
    buffer_load_dwordx4 v11, s[20:23], s26 offen lds
    s_cmp_eq_u32 s51, s14
    s_cselect_b32 s51, 0, s51
    s_add_u32 m0, s27, s51
    s_add_u32 s51, s51, 1024
    buffer_load_dwordx4 v12, s[20:23], s26 offen lds
    s_cmp_eq_u32 s51, s14
    s_cselect_b32 s51, 0, s51
    s_add_u32 m0, s27, s51
    s_add_u32 s51, s51, 1024
    buffer_load_dwordx4 v13, s[20:23], s26 offen lds
    s_cmp_eq_u32 s51, s14
    s_cselect_b32 s51, 0, s51
    s_add_u32 m0, s27, s51
    s_add_u32 s51, s51, 1024
    buffer_load_dwordx4 v14, s[20:23], s26 offen lds
    s_cmp_eq_u32 s51, s14
    s_cselect_b32 s51, 0, s51
    s_add_u32 m0, s27, s51
    s_add_u32 s51, s51, 1024
    buffer_load_dwordx4 v15, s[20:23], s26 offen lds
    s_cmp_eq_u32 s51, s14
    s_cselect_b32 s51, 0, s51
    s_add_u32 m0, s27, s51
    s_add_u32 s51, s51, 1024
    buffer_load_dwordx4 v16, s[20:23], s26 offen lds
    s_cmp_eq_u32 s51, s14
    s_cselect_b32 s51, 0, s51
    s_add_u32 m0, s27, s51
    s_add_u32 s51, s51, 1024
    buffer_load_dwordx4 v17, s[20:23], s26 offen lds
    s_cmp_eq_u32 s51, s14
    s_cselect_b32 s51, 0, s51
    s_add_u32 m0, s27, s51
    s_add_u32 s51, s51, 1024
    buffer_load_dwordx4 v18, s[20:23], s26 offen lds
    s_cmp_eq_u32 s51, s14
    s_cselect_b32 s51, 0, s51
    s_add_u32 m0, s27, s51
    s_add_u32 s51, s51, 1024
    buffer_load_dwordx4 v19, s[20:23], s26 offen lds
    s_cmp_eq_u32 s51, s14
    s_cselect_b32 s51, 0, s51
    s_cbranch_vccz B1_SK
    s_add_u32 m0, s27, s51
    s_add_u32 s51, s51, 1024
    buffer_load_dwordx4 v20, s[20:23], s26 offen lds
    s_cmp_eq_u32 s51, s14
    s_cselect_b32 s51, 0, s51
    s_add_u32 m0, s27, s51
    s_add_u32 s51, s51, 1024
    buffer_load_dwordx4 v21, s[20:23], s26 offen lds
    s_cmp_eq_u32 s51, s14
    s_cselect_b32 s51, 0, s51
B1_SK:
    s_waitcnt vmcnt(10)
    s_barrier
    s_add_u32 s27, s27, 43008
    s_cmp_eq_u32 s27, s48
    s_cselect_b32 s27, s25, s27
    s_add_u32 s26, s26, s24
    s_cmp_eq_u32 s26, s47
    s_cselect_b32 s26, 0, s26
    s_add_u32 s28, s28, 1
    s_cmp_lt_u32 s28, 9
    s_cbranch_scc1 B1_LLOOP
    s_mul_i32 s30, s58, 24
    s_add_u32 s30, s30, s59
    s_lshl_b32 s12, s30, 3
    s_add_u32 s12, s12, 5257216
    s_lshl_b32 s30, s30, 6
    s_add_u32 s11, s30, 5242880
    s_mov_b32 s32, s80
    s_mov_b32 s33, s81
    s_mov_b32 s34, 5312512
    s_mov_b32 s35, 0x20000
    s_mul_i32 s38, s17, 1310720
    s_mul_i32 s30, s18, 5120
    s_add_u32 s38, s38, s30
    s_mov_b32 s41, 40960
    s_mul_i32 s30, s16, 120
    v_mov_b32 v56, 163824
    v_add_u32 v6, s30, v0
    s_movk_i32 s30, 1536
    v_mul_u32_u24 v7, 683, v6
    v_lshrrev_b32 v7, 16, v7
    v_mul_u32_u24 v1, 96, v7
    v_sub_u32 v1, v6, v1
    v_lshlrev_b32 v5, 3, v1
    v_mad_u32_u24 v5, v7, s30, v5
    v_add_u32 v50, 141568, v5
    v_add_u32 v1, s19, v1
    v_lshlrev_b32 v7, 9, v7
    v_lshrrev_b32 v5, 5, v1
    v_mad_u32_u24 v7, v5, s41, v7
    v_and_b32 v5, 31, v1
    v_lshl_add_u32 v7, v5, 4, v7
    v_cmp_le_u32 vcc, s39, v1
    v_cmp_gt_u32 s[36:37], s42, v1
    s_nop 0
    s_and_b64 vcc, vcc, s[36:37]
    v_cndmask_b32 v51, v8, v7, vcc
    v_add_u32 v6, 64, v6
    v_mul_u32_u24 v7, 683, v6
    v_lshrrev_b32 v7, 16, v7
    v_mul_u32_u24 v1, 96, v7
    v_sub_u32 v1, v6, v1
    v_lshlrev_b32 v5, 3, v1
    v_mad_u32_u24 v5, v7, s30, v5
    v_add_u32 v53, 141568, v5
    v_add_u32 v1, s19, v1
    v_lshlrev_b32 v7, 9, v7
    v_lshrrev_b32 v5, 5, v1
    v_mad_u32_u24 v7, v5, s41, v7
    v_and_b32 v5, 31, v1
    v_lshl_add_u32 v7, v5, 4, v7
    v_cmp_le_u32 vcc, s39, v1
    v_cmp_gt_u32 s[36:37], s42, v1
    s_nop 0
    s_and_b64 vcc, vcc, s[36:37]
    s_and_b32 vcc_hi, vcc_hi, 0xffffff
    v_cndmask_b32 v52, v8, v7, vcc
    v_add_u32 v61, -2560, v51
    v_add_u32 v62, -2560, v52
    buffer_load_dword v251, v51, s[32:35], s38 offen
    buffer_load_dword v251, v52, s[32:35], s38 offen
    buffer_load_dword v251, v61, s[32:35], s38 offen
    buffer_load_dword v251, v62, s[32:35], s38 offen
    s_mov_b32 s20, s74
    s_mov_b32 s21, s75
    s_mov_b32 s22, 819200
    s_mov_b32 s23, 0x20000
    s_sub_u32 s30, s59, 4
    s_cmp_ge_u32 s59, 14
    s_cselect_b32 s31, 10, 0
    s_sub_u32 s30, s30, s31
    s_lshl_b32 s30, s30, 7
    s_and_b32 s27, s16, 3
    s_mul_i32 s31, s27, 102400
    s_add_u32 s26, s30, s31
    s_mul_i32 s27, s27, 10240
    s_add_u32 s27, s27, 2048
    v_lshrrev_b32 v6, 3, v0
    v_mul_u32_u24 v6, 1280, v6
    v_and_b32 v7, 7, v0
    v_lshrrev_b32 v1, 2, v0
    v_and_b32 v1, 4, v1
    v_xor_b32 v7, v7, v1
    v_lshl_add_u32 v10, v7, 4, v6
    v_add_u32 v11, 10240, v10
    v_add_u32 v12, 20480, v10
    v_add_u32 v13, 30720, v10
    v_add_u32 v14, 40960, v10
    v_add_u32 v15, 51200, v10
    v_add_u32 v16, 61440, v10
    v_add_u32 v17, 71680, v10
    v_add_u32 v18, 81920, v10
    v_add_u32 v19, 92160, v10
    s_cmp_lt_u32 s59, 4
    s_waitcnt vmcnt(4)
    s_barrier
    s_cbranch_scc1 B1_NOWO
    s_add_u32 m0, s27, 0
    s_nop 0
    buffer_load_dwordx4 v10, s[20:23], s26 offen lds
    s_add_u32 m0, s27, 1024
    s_nop 0
    buffer_load_dwordx4 v11, s[20:23], s26 offen lds
    s_add_u32 m0, s27, 2048
    s_nop 0
    buffer_load_dwordx4 v12, s[20:23], s26 offen lds
    s_add_u32 m0, s27, 3072
    s_nop 0
    buffer_load_dwordx4 v13, s[20:23], s26 offen lds
    s_add_u32 m0, s27, 4096
    s_nop 0
    buffer_load_dwordx4 v14, s[20:23], s26 offen lds
    s_add_u32 m0, s27, 5120
    s_nop 0
    buffer_load_dwordx4 v15, s[20:23], s26 offen lds
    s_add_u32 m0, s27, 6144
    s_nop 0
    buffer_load_dwordx4 v16, s[20:23], s26 offen lds
    s_add_u32 m0, s27, 7168
    s_nop 0
    buffer_load_dwordx4 v17, s[20:23], s26 offen lds
    s_add_u32 m0, s27, 8192
    s_nop 0
    buffer_load_dwordx4 v18, s[20:23], s26 offen lds
    s_add_u32 m0, s27, 9216
    s_nop 0
    buffer_load_dwordx4 v19, s[20:23], s26 offen lds
    s_add_u32 s27, s27, 40960
    s_add_u32 s26, s26, 409600
    s_add_u32 m0, s27, 0
    s_nop 0
    buffer_load_dwordx4 v10, s[20:23], s26 offen lds
    s_add_u32 m0, s27, 1024
    s_nop 0
    buffer_load_dwordx4 v11, s[20:23], s26 offen lds
    s_add_u32 m0, s27, 2048
    s_nop 0
    buffer_load_dwordx4 v12, s[20:23], s26 offen lds
    s_add_u32 m0, s27, 3072
    s_nop 0
    buffer_load_dwordx4 v13, s[20:23], s26 offen lds
    s_add_u32 m0, s27, 4096
    s_nop 0
    buffer_load_dwordx4 v14, s[20:23], s26 offen lds
    s_add_u32 m0, s27, 5120
    s_nop 0
    buffer_load_dwordx4 v15, s[20:23], s26 offen lds
    s_add_u32 m0, s27, 6144
    s_nop 0
    buffer_load_dwordx4 v16, s[20:23], s26 offen lds
    s_add_u32 m0, s27, 7168
    s_nop 0
    buffer_load_dwordx4 v17, s[20:23], s26 offen lds
    s_add_u32 m0, s27, 8192
    s_nop 0
    buffer_load_dwordx4 v18, s[20:23], s26 offen lds
    s_add_u32 m0, s27, 9216
    s_nop 0
    buffer_load_dwordx4 v19, s[20:23], s26 offen lds
B1_NOWO:
    ds_read_b64 v[58:59], v56
    s_waitcnt lgkmcnt(0)
    v_readfirstlane_b32 s10, v58
    v_mov_b32 v252, v59
    v_xor_b32 v253, 0x5bd1e995, v59
    s_cmp_eq_u32 s10, 1
    s_waitcnt lgkmcnt(0)
    s_barrier
    ds_read2_b64 v[64:67], v50 offset1:96
    ds_read2_b64 v[68:71], v53 offset1:96
    s_cbranch_scc1 B1L_NEAR
B1L_FAR:
    s_waitcnt lgkmcnt(1)
    buffer_store_dwordx4 v[64:67], v51, s[32:35], s38 offen sc1
    s_waitcnt lgkmcnt(0)
    buffer_store_dwordx4 v[68:71], v52, s[32:35], s38 offen sc1
    s_waitcnt vmcnt(0)
    s_barrier
    s_cmp_lg_u32 s16, 7
    s_cbranch_scc1 B1_END
    s_mov_b64 exec, 1
    buffer_store_dwordx2 v[252:253], v255, s[32:35], s11 offen sc1
    s_branch B1_END
B1L_NEAR:
    s_waitcnt lgkmcnt(1)
    buffer_store_dwordx4 v[64:67], v51, s[32:35], s38 offen nt
    s_waitcnt lgkmcnt(0)
    buffer_store_dwordx4 v[68:71], v52, s[32:35], s38 offen nt
    s_waitcnt vmcnt(0)
    s_barrier
    s_cmp_lg_u32 s16, 7
    s_cbranch_scc1 B1_END
    s_mov_b64 exec, 1
    buffer_store_dwordx2 v[252:253], v255, s[32:35], s12 offen
B1_END:
    s_endpgm
B1_X:
    s_mov_b32 s25, 0
    s_mov_b32 s27, 86016
    s_lshl_b32 s24, s19, 1
    s_add_u32 s24, s24, s17
    s_mul_i32 s24, s24, 1280
    v_lshrrev_b32 v2, 3, v0
    v_mul_u32_u24 v2, 2560, v2
    v_add_u32 v2, s24, v2
    v_lshrrev_b32 v3, 4, v0
    v_and_b32 v4, 7, v0
    v_xor_b32 v3, v3, v4
    v_lshl_add_u32 v10, v3, 4, v2
    v_xor_b32 v3, 64, v10
    s_movk_i32 s24, 128
    s_lshl_b32 s26, s26, 7
    s_waitcnt lgkmcnt(0)
    s_mov_b32 s20, s70
    s_mov_b32 s21, s71
    s_mov_b32 s22, 2621440
    s_mov_b32 s23, 0x20000
    s_add_u32 m0, s27, 0
    v_add_u32 v11, 20480, v3
    buffer_load_dwordx4 v10, s[20:23], s26 offen lds
    s_add_u32 m0, s27, 1024
    v_add_u32 v12, 40960, v10
    buffer_load_dwordx4 v11, s[20:23], s26 offen lds
    s_add_u32 m0, s27, 2048
    v_add_u32 v13, 61440, v3
    buffer_load_dwordx4 v12, s[20:23], s26 offen lds
    s_add_u32 m0, s27, 3072
    v_add_u32 v14, 81920, v10
    buffer_load_dwordx4 v13, s[20:23], s26 offen lds
    s_add_u32 m0, s27, 4096
    v_add_u32 v15, 102400, v3
    buffer_load_dwordx4 v14, s[20:23], s26 offen lds
    s_add_u32 m0, s27, 5120
    v_add_u32 v16, 122880, v10
    buffer_load_dwordx4 v15, s[20:23], s26 offen lds
    s_add_u32 m0, s27, 6144
    v_add_u32 v17, 143360, v3
    buffer_load_dwordx4 v16, s[20:23], s26 offen lds
    s_add_u32 m0, s27, 7168
    v_add_u32 v18, 163840, v10
    buffer_load_dwordx4 v17, s[20:23], s26 offen lds
    s_add_u32 m0, s27, 8192
    v_add_u32 v19, 184320, v3
    buffer_load_dwordx4 v18, s[20:23], s26 offen lds
    s_add_u32 m0, s27, 9216
    v_add_u32 v20, 204800, v10
    buffer_load_dwordx4 v19, s[20:23], s26 offen lds
    s_add_u32 m0, s27, 10240
    v_add_u32 v21, 225280, v3
    buffer_load_dwordx4 v20, s[20:23], s26 offen lds
    s_add_u32 m0, s27, 11264
    s_nop 0
    buffer_load_dwordx4 v21, s[20:23], s26 offen lds
    s_mul_i32 s5, s59, 110
    v_add_u32 v2, s5, v0
    v_mul_u32_u24 v3, 6554, v2
    v_lshrrev_b32 v3, 16, v3
    v_mul_u32_u24 v3, 1280, v3
    v_lshl_add_u32 v2, v2, 7, v3
    s_max_u32 s5, s46, 8
    s_sub_u32 s5, s5, 8
    s_lshl_b32 s5, s5, 1
    s_add_u32 s5, s5, s17
    s_mul_i32 s5, s5, 1280
    s_add_u32 s6, s5, 15360
    s_mov_b32 exec_hi, 0xfffffff
    buffer_load_dword v251, v2, s[20:23], s5 offen
    s_mov_b32 exec_hi, 0x3ffff
    buffer_load_dword v251, v2, s[20:23], s6 offen
    s_mov_b32 exec_hi, -1
    s_mov_b64 vcc, -1
    s_mov_b32 s51, 0
    s_movk_i32 s14, 12288
    s_branch B1_GO
B1_PROD:
    s_waitcnt lgkmcnt(0)
    v_mov_b32 v64, 0
    v_mov_b32 v65, 0
    v_mov_b32 v66, 0
    v_mov_b32 v67, 0
    v_mov_b32 v68, 0
    v_mov_b32 v69, 0
    v_mov_b32 v70, 0
    v_mov_b32 v71, 0
    v_mov_b32 v72, 0
    v_mov_b32 v73, 0
    v_mov_b32 v74, 0
    v_mov_b32 v75, 0
    v_mov_b32 v76, 0
    v_mov_b32 v77, 0
    v_mov_b32 v78, 0
    v_mov_b32 v79, 0
    v_mov_b32 v80, 0
    v_mov_b32 v81, 0
    v_mov_b32 v82, 0
    v_mov_b32 v83, 0
    v_mov_b32 v84, 0
    v_mov_b32 v85, 0
    v_mov_b32 v86, 0
    v_mov_b32 v87, 0
    v_mov_b32 v88, 0
    v_mov_b32 v89, 0
    v_mov_b32 v90, 0
    v_mov_b32 v91, 0
    v_mov_b32 v92, 0
    v_mov_b32 v93, 0
    v_mov_b32 v94, 0
    v_mov_b32 v95, 0
    v_mov_b32 v96, 0
    v_mov_b32 v97, 0
    v_mov_b32 v98, 0
    v_mov_b32 v99, 0
    v_mov_b32 v100, 0
    v_mov_b32 v101, 0
    v_mov_b32 v102, 0
    v_mov_b32 v103, 0
    v_mov_b32 v104, 0
    v_mov_b32 v105, 0
    v_mov_b32 v106, 0
    v_mov_b32 v107, 0
    v_mov_b32 v108, 0
    v_mov_b32 v109, 0
    v_mov_b32 v110, 0
    v_mov_b32 v111, 0
    v_mov_b32 v112, 0
    v_mov_b32 v113, 0
    v_mov_b32 v114, 0
    v_mov_b32 v115, 0
    v_mov_b32 v116, 0
    v_mov_b32 v117, 0
    v_mov_b32 v118, 0
    v_mov_b32 v119, 0
    v_mov_b32 v120, 0
    v_mov_b32 v121, 0
    v_mov_b32 v122, 0
    v_mov_b32 v123, 0
    v_mov_b32 v124, 0
    v_mov_b32 v125, 0
    v_mov_b32 v126, 0
    v_mov_b32 v127, 0
    v_mov_b32 v128, 0
    v_mov_b32 v129, 0
    v_mov_b32 v130, 0
    v_mov_b32 v131, 0
    v_mov_b32 v132, 0
    v_mov_b32 v133, 0
    v_mov_b32 v134, 0
    v_mov_b32 v135, 0
    v_mov_b32 v136, 0
    v_mov_b32 v137, 0
    v_mov_b32 v138, 0
    v_mov_b32 v139, 0
    v_mov_b32 v140, 0
    v_mov_b32 v141, 0
    v_mov_b32 v142, 0
    v_mov_b32 v143, 0
    v_mov_b32 v144, 0
    v_mov_b32 v145, 0
    v_mov_b32 v146, 0
    v_mov_b32 v147, 0
    v_mov_b32 v148, 0
    v_mov_b32 v149, 0
    v_mov_b32 v150, 0
    v_mov_b32 v151, 0
    v_mov_b32 v152, 0
    v_mov_b32 v153, 0
    v_mov_b32 v154, 0
    v_mov_b32 v155, 0
    v_mov_b32 v156, 0
    v_mov_b32 v157, 0
    v_mov_b32 v158, 0
    v_mov_b32 v159, 0
    v_and_b32 v2, 15, v0
    v_lshrrev_b32 v3, 4, v0
    v_mov_b32 v4, 0
    v_lshlrev_b32 v6, 2, v3
    v_sub_u32 v6, v6, v2
    v_mov_b32 v7, 0xf149f2ca
    v_mov_b32 v5, 0xffff
    v_mov_b32 v31, 0xffff0000
    v_cmp_le_i32 vcc, 9, v6
    v_add_u32 v1, 7, v6
    v_mov_b32 v44, 0x3f803f80
    v_cndmask_b32 v32, v7, v4, vcc
    v_cndmask_b32 v54, 0, v5, vcc
    v_cmp_ge_u32 vcc, 7, v1
    v_mov_b32 v40, v7
    s_nop 0
    v_cndmask_b32 v36, v7, v4, vcc
    v_cmp_le_i32 vcc, 8, v6
    v_add_u32 v1, 8, v6
    v_mov_b32 v45, 0x3f803f80
    v_cndmask_b32 v33, v7, v4, vcc
    v_cndmask_b32 v57, 0, v31, vcc
    v_cmp_ge_u32 vcc, 7, v1
    v_mov_b32 v41, v7
    v_or_b32 v54, v54, v57
    v_cndmask_b32 v37, v7, v4, vcc
    v_cmp_le_i32 vcc, 7, v6
    v_add_u32 v1, 9, v6
    v_mov_b32 v46, 0x3f803f80
    v_cndmask_b32 v34, v7, v4, vcc
    v_cndmask_b32 v55, 0, v5, vcc
    v_cmp_ge_u32 vcc, 7, v1
    v_mov_b32 v42, v7
    s_nop 0
    v_cndmask_b32 v38, v7, v4, vcc
    v_cmp_le_i32 vcc, 6, v6
    v_add_u32 v1, 10, v6
    v_mov_b32 v47, 0x3f803f80
    v_cndmask_b32 v35, v7, v4, vcc
    v_cndmask_b32 v57, 0, v31, vcc
    v_cmp_ge_u32 vcc, 7, v1
    v_mov_b32 v43, v7
    v_or_b32 v55, v55, v57
    v_cndmask_b32 v39, v7, v4, vcc
    s_mul_i32 s31, s16, 3840
    s_add_u32 s31, s31, 141568
    v_lshl_add_u32 v6, v2, 3, s31
    v_mul_u32_u24 v7, 768, v3
    v_add_u32 v48, v6, v7
    v_add_u32 v6, 3072, v6
    v_lshl_add_u32 v49, v3, 7, v6
    v_add_u32 v7, 512, v49
    v_mov_b32 v6, 0x40000
    v_cmp_gt_u32 vcc, 2, v3
    s_nop 1
    v_cndmask_b32 v23, v6, v7, vcc
    v_cmp_eq_u32 vcc, 0, v3
    s_nop 1
    v_cndmask_b32_e64 v30, 0, -1, vcc
    s_mul_i32 s30, s16, 768
    s_add_u32 s30, s30, 129024
    v_lshl_add_u32 v7, v2, 3, s30
    v_cmp_eq_u32 vcc, 2, v3
    s_nop 1
    v_cndmask_b32 v24, v6, v7, vcc
    v_lshrrev_b32 v7, 2, v0
    v_lshl_add_u32 v4, v7, 3, s30
    v_and_b32 v5, 3, v0
    v_mov_b32 v6, 132096
    v_lshl_add_u32 v1, v0, 4, v6
    ds_write_b128 v1, v[64:67]
    v_cmp_eq_u32 vcc, 0, v5
    s_nop 1
    v_cndmask_b32 v25, v6, v4, vcc
    v_cmp_eq_u32 vcc, 1, v5
    s_nop 1
    v_cndmask_b32 v26, v6, v4, vcc
    v_cmp_eq_u32 vcc, 2, v5
    s_nop 1
    v_cndmask_b32 v27, v6, v4, vcc
    v_cmp_eq_u32 vcc, 3, v5
    s_nop 1
    v_cndmask_b32 v28, v6, v4, vcc
    s_mov_b32 s40, 0x3ea52b5c
    s_mov_b32 s44, 0xffff0000
    s_mov_b32 s45, 0
    s_mov_b32 s46, 0
    s_mov_b32 s47, 0xffff
    s_mov_b32 s48, 0
    s_mov_b32 s49, 0xffff0000
    v_lshrrev_b32 v4, 1, v2
    v_xor_b32 v4, v4, v3
    v_lshlrev_b32 v4, 4, v4
    v_lshl_add_u32 v16, v2, 7, v4
    v_xor_b32 v17, 64, v16
    v_mul_u32_u24 v7, 480, v7
    s_mul_i32 s28, s16, 40
    v_add_u32 v7, s28, v7
    v_and_b32 v5, 3, v0
    v_lshl_add_u32 v18, v5, 3, v7
    v_min_u32 v5, 2, v5
    v_mul_u32_u24 v5, 160, v5
    v_add3_u32 v15, v7, v5, 32
    v_add_u32 v19, 86016, v16
    v_add_u32 v20, 86016, v17
    v_add_u32 v21, 86016, v18
    v_add_u32 v22, 86016, v15
    s_waitcnt lgkmcnt(0)
    s_mov_b32 s32, s80
    s_mov_b32 s33, s81
    s_mov_b32 s34, 5312512
    s_mov_b32 s35, 0x20000
    s_mul_i32 s38, s17, 1310720
    s_mul_i32 s30, s18, 5120
    s_add_u32 s38, s38, s30
    s_mov_b32 s41, 40960
    s_mul_i32 s30, s16, 120
    v_mov_b32 v56, 163824
    v_add_u32 v6, s30, v0
    s_movk_i32 s30, 1536
    v_mul_u32_u24 v7, 683, v6
    v_lshrrev_b32 v7, 16, v7
    v_mul_u32_u24 v1, 96, v7
    v_sub_u32 v1, v6, v1
    v_lshlrev_b32 v5, 3, v1
    v_mad_u32_u24 v5, v7, s30, v5
    v_add_u32 v50, 141568, v5
    v_add_u32 v1, s19, v1
    v_lshlrev_b32 v7, 9, v7
    v_lshrrev_b32 v5, 5, v1
    v_mad_u32_u24 v7, v5, s41, v7
    v_and_b32 v5, 31, v1
    v_lshl_add_u32 v7, v5, 4, v7
    v_cmp_le_u32 vcc, s39, v1
    v_cmp_gt_u32 s[36:37], s42, v1
    s_nop 0
    s_and_b64 vcc, vcc, s[36:37]
    v_cndmask_b32 v51, v8, v7, vcc
    v_add_u32 v6, 64, v6
    v_mul_u32_u24 v7, 683, v6
    v_lshrrev_b32 v7, 16, v7
    v_mul_u32_u24 v1, 96, v7
    v_sub_u32 v1, v6, v1
    v_lshlrev_b32 v5, 3, v1
    v_mad_u32_u24 v5, v7, s30, v5
    v_add_u32 v53, 141568, v5
    v_add_u32 v1, s19, v1
    v_lshlrev_b32 v7, 9, v7
    v_lshrrev_b32 v5, 5, v1
    v_mad_u32_u24 v7, v5, s41, v7
    v_and_b32 v5, 31, v1
    v_lshl_add_u32 v7, v5, 4, v7
    v_cmp_le_u32 vcc, s39, v1
    v_cmp_gt_u32 s[36:37], s42, v1
    s_nop 0
    s_and_b64 vcc, vcc, s[36:37]
    s_and_b32 vcc_hi, vcc_hi, 0xffffff
    v_cndmask_b32 v52, v8, v7, vcc
    s_cmp_ge_u32 s59, 14
    s_cselect_b32 s18, 14, 4
    s_cselect_b32 s22, 4, 0
    s_sub_u32 s18, s59, s18
    s_add_u32 s22, s22, s16
    s_and_b32 s19, s58, 3
    s_lshl_b32 s19, s19, 3
    s_add_u32 s19, s19, s22
    s_lshl_b32 s20, s17, 5
    s_add_u32 s20, s20, s19
    s_mul_i32 s20, s20, 40960
    v_lshlrev_b32 v2, 4, v0
    v_lshrrev_b32 v4, 3, v0
    v_and_b32 v5, 7, v0
    s_mov_b32 s24, s76
    s_mov_b32 s25, s77
    s_mov_b32 s26, 5242880
    s_mov_b32 s27, 0x20000
    v_lshrrev_b32 v7, 5, v0
    v_lshlrev_b32 v7, 10, v7
    v_bfe_u32 v8, v0, 2, 2
    v_lshl_add_u32 v7, v8, 7, v7
    v_lshrrev_b32 v8, 1, v8
    v_lshl_add_u32 v7, v8, 6, v7
    v_bfe_u32 v8, v0, 4, 1
    v_lshl_add_u32 v7, v8, 5, v7
    v_and_b32 v8, 3, v0
    v_lshl_add_u32 v7, v8, 3, v7
    v_add_u32 v7, 2048, v7
    v_xor_b32 v8, 64, v7
    v_mul_u32_u24 v3, 31, v4
    s_lshl_b32 s22, s22, 5
    v_add_u32 v3, s22, v3
    v_cmp_le_u32 vcc, 88, v3
    s_nop 1
    v_cndmask_b32_e64 v12, 0, 1, vcc
    v_cmp_le_u32 vcc, 176, v3
    s_nop 1
    v_cndmask_b32_e64 v3, v12, 2, vcc
    s_mul_i32 s22, s58, 3
    v_add_u32 v3, s22, v3
    v_lshl_add_u32 v3, v3, 3, v5
    v_lshlrev_b32 v3, 6, v3
    s_lshl_b32 s36, s16, 12
    s_add_u32 s36, s36, 86016
    v_and_b32 v12, 31, v0
    v_lshlrev_b32 v9, 7, v12
    v_lshl_add_u32 v9, v5, 4, v9
    v_lshrrev_b32 v13, 5, v0
    v_lshl_add_u32 v9, v13, 3, v9
    v_add_u32 v9, s36, v9
    v_xor_b32 v10, v5, v4
    v_lshlrev_b32 v10, 4, v10
    v_lshl_add_u32 v10, v4, 7, v10
    v_add_u32 v10, s36, v10
    v_mul_u32_u24 v11, 5120, v4
    v_lshl_add_u32 v11, v5, 4, v11
    s_mul_i32 s37, s19, 163840
    s_mul_i32 s21, s17, 2560
    s_add_u32 s37, s37, s21
    s_lshl_b32 s21, s18, 7
    s_add_u32 s37, s37, s21
    s_add_u32 s37, s37, 1280
    s_mov_b32 s8, 5242880
    s_mov_b32 s52, s78
    s_mov_b32 s53, s79
    s_mov_b32 s54, 256
    s_mov_b32 s55, 0x20000
    s_lshl_b32 s9, s58, 8
    s_add_u32 s9, s9, 5259264
    v_lshlrev_b32 v60, 3, v0
    s_getreg_b32 s50, hwreg(HW_REG_XCC_ID, 0, 4)
    s_add_u32 s50, s50, 1
    s_mul_i32 s30, s58, 24
    s_add_u32 s30, s30, s59
    s_lshl_b32 s30, s30, 3
    s_add_u32 s11, s30, 5257216
    s_mov_b32 s28, 0
    s_mov_b32 s30, 0
    s_barrier
    ds_read_b64_tr_b16 v[208:209], v21 offset:12288
    ds_read_b64_tr_b16 v[210:211], v21 offset:19968
    ds_read_b128 v[160:163], v19
    ds_read_b64_tr_b16 v[212:213], v21 offset:12448
    ds_read_b64_tr_b16 v[214:215], v21 offset:20128
    ds_read_b64_tr_b16 v[216:217], v21 offset:12608
    ds_read_b64_tr_b16 v[218:219], v21 offset:20288
    ds_read_b64_tr_b16 v[220:221], v22 offset:12288
    ds_read_b64_tr_b16 v[222:223], v22 offset:19968
    ds_read_b128 v[164:167], v19 offset:2048
    ds_read_b128 v[168:171], v19 offset:4096
    ds_read_b128 v[172:175], v19 offset:6144
    ds_read_b128 v[176:179], v19 offset:8192
    ds_read_b128 v[180:183], v19 offset:10240
    s_branch B1_MID
B1_LOOP:
    v_mfma_f32_16x16x32_bf16 v[64:67], v[224:227], v[184:187], v[64:67]
    v_mfma_f32_16x16x32_bf16 v[88:91], v[228:231], v[184:187], v[88:91]
    v_mfma_f32_16x16x32_bf16 v[112:115], v[184:187], v[232:235], v[112:115]
    v_mfma_f32_16x16x32_bf16 v[136:139], v[236:239], v[184:187], v[136:139]
    v_mfma_f32_16x16x32_bf16 v[68:71], v[224:227], v[188:191], v[68:71]
    v_mfma_f32_16x16x32_bf16 v[92:95], v[228:231], v[188:191], v[92:95]
    v_mfma_f32_16x16x32_bf16 v[116:119], v[188:191], v[232:235], v[116:119]
    v_mfma_f32_16x16x32_bf16 v[140:143], v[236:239], v[188:191], v[140:143]
    v_mfma_f32_16x16x32_bf16 v[72:75], v[224:227], v[192:195], v[72:75]
    v_mfma_f32_16x16x32_bf16 v[96:99], v[228:231], v[192:195], v[96:99]
    s_barrier
    v_mfma_f32_16x16x32_bf16 v[120:123], v[192:195], v[232:235], v[120:123]
    ds_read_b64_tr_b16 v[208:209], v21 offset:12288
    v_mfma_f32_16x16x32_bf16 v[144:147], v[236:239], v[192:195], v[144:147]
    ds_read_b64_tr_b16 v[210:211], v21 offset:19968
    v_mfma_f32_16x16x32_bf16 v[76:79], v[224:227], v[196:199], v[76:79]
    ds_read_b128 v[160:163], v19
    v_mfma_f32_16x16x32_bf16 v[100:103], v[228:231], v[196:199], v[100:103]
    ds_read_b64_tr_b16 v[212:213], v21 offset:12448
    v_mfma_f32_16x16x32_bf16 v[124:127], v[196:199], v[232:235], v[124:127]
    ds_read_b64_tr_b16 v[214:215], v21 offset:20128
    v_mfma_f32_16x16x32_bf16 v[148:151], v[236:239], v[196:199], v[148:151]
    ds_read_b64_tr_b16 v[216:217], v21 offset:12608
    v_mfma_f32_16x16x32_bf16 v[80:83], v[224:227], v[200:203], v[80:83]
    ds_read_b64_tr_b16 v[218:219], v21 offset:20288
    v_mfma_f32_16x16x32_bf16 v[104:107], v[228:231], v[200:203], v[104:107]
    ds_read_b64_tr_b16 v[220:221], v22 offset:12288
    v_mfma_f32_16x16x32_bf16 v[128:131], v[200:203], v[232:235], v[128:131]
    ds_read_b64_tr_b16 v[222:223], v22 offset:19968
    v_mfma_f32_16x16x32_bf16 v[152:155], v[236:239], v[200:203], v[152:155]
    ds_read_b128 v[164:167], v19 offset:2048
    v_mfma_f32_16x16x32_bf16 v[84:87], v[224:227], v[204:207], v[84:87]
    ds_read_b128 v[168:171], v19 offset:4096
    v_mfma_f32_16x16x32_bf16 v[108:111], v[228:231], v[204:207], v[108:111]
    ds_read_b128 v[172:175], v19 offset:6144
    v_mfma_f32_16x16x32_bf16 v[132:135], v[204:207], v[232:235], v[132:135]
    ds_read_b128 v[176:179], v19 offset:8192
    v_mfma_f32_16x16x32_bf16 v[156:159], v[236:239], v[204:207], v[156:159]
    ds_read_b128 v[180:183], v19 offset:10240
B1_MID:
    s_waitcnt lgkmcnt(5)
    v_mfma_f32_16x16x32_bf16 v[64:67], v[208:211], v[160:163], v[64:67]
    ds_read_b64_tr_b16 v[224:225], v21 offset:27648
    v_mfma_f32_16x16x32_bf16 v[88:91], v[212:215], v[160:163], v[88:91]
    ds_read_b64_tr_b16 v[226:227], v21 offset:35328
    v_mfma_f32_16x16x32_bf16 v[112:115], v[160:163], v[216:219], v[112:115]
    ds_read_b128 v[184:187], v20
    v_mfma_f32_16x16x32_bf16 v[136:139], v[220:223], v[160:163], v[136:139]
    ds_read_b64_tr_b16 v[228:229], v21 offset:27808
    s_waitcnt lgkmcnt(8)
    v_mfma_f32_16x16x32_bf16 v[68:71], v[208:211], v[164:167], v[68:71]
    ds_read_b64_tr_b16 v[230:231], v21 offset:35488
    v_mfma_f32_16x16x32_bf16 v[92:95], v[212:215], v[164:167], v[92:95]
    ds_read_b64_tr_b16 v[232:233], v21 offset:27968
    v_mfma_f32_16x16x32_bf16 v[116:119], v[164:167], v[216:219], v[116:119]
    ds_read_b64_tr_b16 v[234:235], v21 offset:35648
    v_mfma_f32_16x16x32_bf16 v[140:143], v[220:223], v[164:167], v[140:143]
    ds_read_b64_tr_b16 v[236:237], v22 offset:27648
    s_waitcnt lgkmcnt(11)
    v_mfma_f32_16x16x32_bf16 v[72:75], v[208:211], v[168:171], v[72:75]
    ds_read_b64_tr_b16 v[238:239], v22 offset:35328
    v_mfma_f32_16x16x32_bf16 v[96:99], v[212:215], v[168:171], v[96:99]
    ds_read_b128 v[188:191], v20 offset:2048
    v_mfma_f32_16x16x32_bf16 v[120:123], v[168:171], v[216:219], v[120:123]
    ds_read_b128 v[192:195], v20 offset:4096
    v_mfma_f32_16x16x32_bf16 v[144:147], v[220:223], v[168:171], v[144:147]
    ds_read_b128 v[196:199], v20 offset:6144
    s_waitcnt lgkmcnt(14)
    v_mfma_f32_16x16x32_bf16 v[76:79], v[208:211], v[172:175], v[76:79]
    ds_read_b128 v[200:203], v20 offset:8192
    v_mfma_f32_16x16x32_bf16 v[100:103], v[212:215], v[172:175], v[100:103]
    ds_read_b128 v[204:207], v20 offset:10240
    v_mfma_f32_16x16x32_bf16 v[124:127], v[172:175], v[216:219], v[124:127]
    v_mfma_f32_16x16x32_bf16 v[148:151], v[220:223], v[172:175], v[148:151]
    v_add_u32 v19, s30, v16
    v_add_u32 v20, s30, v17
    s_waitcnt lgkmcnt(15)
    v_mfma_f32_16x16x32_bf16 v[80:83], v[208:211], v[176:179], v[80:83]
    v_add_u32 v21, s30, v18
    v_add_u32 v22, s30, v15
    v_mfma_f32_16x16x32_bf16 v[104:107], v[212:215], v[176:179], v[104:107]
    s_add_u32 s30, s30, 43008
    s_cmp_eq_u32 s30, 129024
    v_mfma_f32_16x16x32_bf16 v[128:131], v[176:179], v[216:219], v[128:131]
    s_cselect_b32 s30, 0, s30
    s_add_u32 s28, s28, 1
    v_mfma_f32_16x16x32_bf16 v[152:155], v[220:223], v[176:179], v[152:155]
    s_nop 0
    s_waitcnt lgkmcnt(14)
    v_mfma_f32_16x16x32_bf16 v[84:87], v[208:211], v[180:183], v[84:87]
    v_mfma_f32_16x16x32_bf16 v[108:111], v[212:215], v[180:183], v[108:111]
    v_mfma_f32_16x16x32_bf16 v[132:135], v[180:183], v[216:219], v[132:135]
    v_mfma_f32_16x16x32_bf16 v[156:159], v[220:223], v[180:183], v[156:159]
    s_cmp_lg_u32 s16, 0
    s_cbranch_scc1 B1_NOTAB
    s_cmp_lg_u32 s28, 2
    s_cbranch_scc1 B1_NOT1
    buffer_load_dword v252, v255, s[52:55], 0 offen sc1
B1_NOT1:
    s_cmp_lg_u32 s28, 4
    s_cbranch_scc1 B1_NOT3
    s_waitcnt vmcnt(0)
    s_mov_b32 s4, 0
B1_NONCE:
    v_readfirstlane_b32 s5, v252
    s_nop 0
    s_cmp_lg_u32 s5, 0
    s_cbranch_scc1 B1_TAG
    s_add_u32 s4, s4, 1
    s_cmp_gt_u32 s4, 0x40000
    s_cbranch_scc1 B1_TAG
    buffer_load_dword v252, v255, s[52:55], 0 offen sc1
    s_waitcnt vmcnt(0)
    s_branch B1_NONCE
B1_TAG:
    v_xor_b32 v253, 0x5bd1e995, v252
    v_mov_b32 v4, v252
    v_xor_b32 v5, s50, v253
    s_lshl_b32 s10, s59, 3
    s_add_u32 s10, s10, s9
    s_mov_b64 exec, 1
    buffer_store_dwordx2 v[4:5], v255, s[32:35], s10 offen sc1
    s_mov_b64 exec, -1
B1_NOT3:
    s_cmp_lg_u32 s28, 7
    s_cbranch_scc1 B1_NOT6
    buffer_load_dwordx2 v[58:59], v60, s[32:35], s9 offen sc1
    buffer_load_dword v251, v255, s[32:35], s11 offen
B1_NOT6:
    s_cmp_lg_u32 s28, 9
    s_cbranch_scc1 B1_NOTAB
    s_mov_b32 exec_lo, 0xffffff
    s_mov_b32 exec_hi, 0
    s_mov_b32 s4, 0
    s_waitcnt vmcnt(1)
B1_TAB:
    v_cmp_ne_u32 vcc, v58, v252
    s_nop 0
    s_cmp_eq_u64 vcc, 0
    s_cbranch_scc1 B1_TABOK
    buffer_load_dwordx2 v[58:59], v60, s[32:35], s9 offen sc1
    s_add_u32 s4, s4, 1
    s_cmp_lt_u32 s4, 0x40000
    s_waitcnt vmcnt(0)
    s_cbranch_scc1 B1_TAB
B1_TABOK:
    v_cmp_ne_u32 vcc, v59, v5
    s_nop 0
    s_cmp_eq_u64 vcc, 0
    s_cselect_b32 s10, 1, 0
    v_mov_b32 v4, s10
    v_mov_b32 v5, v252
    ds_write_b64 v56, v[4:5]
    s_mov_b64 exec, -1
B1_NOTAB:
    s_cmp_lt_u32 s28, 10
    s_waitcnt lgkmcnt(0)
    s_cbranch_scc1 B1_LOOP
    v_mfma_f32_16x16x32_bf16 v[64:67], v[224:227], v[184:187], v[64:67]
    v_mfma_f32_16x16x32_bf16 v[88:91], v[228:231], v[184:187], v[88:91]
    v_mfma_f32_16x16x32_bf16 v[112:115], v[184:187], v[232:235], v[112:115]
    v_mfma_f32_16x16x32_bf16 v[136:139], v[236:239], v[184:187], v[136:139]
    v_mfma_f32_16x16x32_bf16 v[68:71], v[224:227], v[188:191], v[68:71]
    s_nop 3
    v_cvt_pk_bf16_f32 v64, v64, v65
    v_cvt_pk_bf16_f32 v65, v66, v67
    v_cvt_pk_bf16_f32 v160, v88, v89
    v_cvt_pk_bf16_f32 v161, v90, v91
    v_mfma_f32_16x16x32_bf16 v[92:95], v[228:231], v[188:191], v[92:95]
    v_cvt_pk_bf16_f32 v210, v112, v113
    v_cvt_pk_bf16_f32 v211, v114, v115
    v_cvt_pk_bf16_f32 v136, v136, v137
    v_cvt_pk_bf16_f32 v137, v138, v139
    v_mfma_f32_16x16x32_bf16 v[116:119], v[188:191], v[232:235], v[116:119]
    v_and_b32 v66, v136, v30
    v_and_b32 v67, v137, v30
    v_permlane16_swap_b32 v136, v162
    v_permlane16_swap_b32 v137, v163
    v_mfma_f32_16x16x32_bf16 v[140:143], v[236:239], v[188:191], v[140:143]
    ds_write_b64 v24, v[136:137] offset:0
    v_mfma_f32_16x16x32_bf16 v[112:115], v[160:163], v[64:67], v[36:39]
    v_mfma_f32_16x16x32_bf16 v[88:91], v[160:163], v[64:67], v[40:43]
    v_mfma_f32_16x16x32_bf16 v[72:75], v[224:227], v[192:195], v[72:75]
    v_cvt_pk_bf16_f32 v68, v68, v69
    v_cvt_pk_bf16_f32 v69, v70, v71
    v_cvt_pk_bf16_f32 v164, v92, v93
    v_cvt_pk_bf16_f32 v165, v94, v95
    v_mfma_f32_16x16x32_bf16 v[96:99], v[228:231], v[192:195], v[96:99]
    v_cvt_pk_bf16_f32 v212, v116, v117
    v_cvt_pk_bf16_f32 v213, v118, v119
    v_cvt_pk_bf16_f32 v140, v140, v141
    v_cvt_pk_bf16_f32 v141, v142, v143
    v_mfma_f32_16x16x32_bf16 v[120:123], v[192:195], v[232:235], v[120:123]
    v_and_b32 v70, v140, v30
    v_and_b32 v71, v141, v30
    v_permlane16_swap_b32 v140, v166
    v_permlane16_swap_b32 v141, v167
    v_mfma_f32_16x16x32_bf16 v[144:147], v[236:239], v[192:195], v[144:147]
    ds_write_b64 v24, v[140:141] offset:128
    v_mfma_f32_16x16x32_bf16 v[116:119], v[164:167], v[68:71], v[36:39]
    v_mfma_f32_16x16x32_bf16 v[92:95], v[160:163], v[68:71], v[32:35]
    v_mfma_f32_16x16x32_bf16 v[76:79], v[224:227], v[196:199], v[76:79]
    v_cvt_pk_bf16_f32 v72, v72, v73
    v_cvt_pk_bf16_f32 v73, v74, v75
    v_cvt_pk_bf16_f32 v168, v96, v97
    v_cvt_pk_bf16_f32 v169, v98, v99
    v_mfma_f32_16x16x32_bf16 v[100:103], v[228:231], v[196:199], v[100:103]
    v_cvt_pk_bf16_f32 v214, v120, v121
    v_cvt_pk_bf16_f32 v215, v122, v123
    v_cvt_pk_bf16_f32 v144, v144, v145
    v_cvt_pk_bf16_f32 v145, v146, v147
    v_mfma_f32_16x16x32_bf16 v[124:127], v[196:199], v[232:235], v[124:127]
    v_and_b32 v74, v144, v30
    v_and_b32 v75, v145, v30
    v_permlane16_swap_b32 v144, v170
    v_permlane16_swap_b32 v145, v171
    v_mfma_f32_16x16x32_bf16 v[148:151], v[236:239], v[196:199], v[148:151]
    ds_write_b64 v24, v[144:145] offset:256
    v_mfma_f32_16x16x32_bf16 v[120:123], v[168:171], v[72:75], v[36:39]
    v_mfma_f32_16x16x32_bf16 v[96:99], v[164:167], v[72:75], v[32:35]
    v_mfma_f32_16x16x32_bf16 v[80:83], v[224:227], v[200:203], v[80:83]
    v_cvt_pk_bf16_f32 v76, v76, v77
    v_cvt_pk_bf16_f32 v77, v78, v79
    v_cvt_pk_bf16_f32 v172, v100, v101
    v_cvt_pk_bf16_f32 v173, v102, v103
    v_mfma_f32_16x16x32_bf16 v[104:107], v[228:231], v[200:203], v[104:107]
    v_cvt_pk_bf16_f32 v216, v124, v125
    v_cvt_pk_bf16_f32 v217, v126, v127
    v_cvt_pk_bf16_f32 v148, v148, v149
    v_cvt_pk_bf16_f32 v149, v150, v151
    v_mfma_f32_16x16x32_bf16 v[128:131], v[200:203], v[232:235], v[128:131]
    v_and_b32 v78, v148, v30
    v_and_b32 v79, v149, v30
    v_permlane16_swap_b32 v148, v174
    v_permlane16_swap_b32 v149, v175
    v_mfma_f32_16x16x32_bf16 v[152:155], v[236:239], v[200:203], v[152:155]
    ds_write_b64 v24, v[148:149] offset:384
    v_mfma_f32_16x16x32_bf16 v[124:127], v[172:175], v[76:79], v[36:39]
    v_mfma_f32_16x16x32_bf16 v[100:103], v[168:171], v[76:79], v[32:35]
    v_mfma_f32_16x16x32_bf16 v[84:87], v[224:227], v[204:207], v[84:87]
    v_cvt_pk_bf16_f32 v80, v80, v81
    v_cvt_pk_bf16_f32 v81, v82, v83
    v_cvt_pk_bf16_f32 v176, v104, v105
    v_cvt_pk_bf16_f32 v177, v106, v107
    v_mfma_f32_16x16x32_bf16 v[108:111], v[228:231], v[204:207], v[108:111]
    v_cvt_pk_bf16_f32 v218, v128, v129
    v_cvt_pk_bf16_f32 v219, v130, v131
    v_cvt_pk_bf16_f32 v152, v152, v153
    v_cvt_pk_bf16_f32 v153, v154, v155
    v_mfma_f32_16x16x32_bf16 v[132:135], v[204:207], v[232:235], v[132:135]
    v_and_b32 v82, v152, v30
    v_and_b32 v83, v153, v30
    v_permlane16_swap_b32 v152, v178
    v_permlane16_swap_b32 v153, v179
    v_mfma_f32_16x16x32_bf16 v[156:159], v[236:239], v[204:207], v[156:159]
    ds_write_b64 v24, v[152:153] offset:512
    v_mfma_f32_16x16x32_bf16 v[128:131], v[176:179], v[80:83], v[36:39]
    v_mfma_f32_16x16x32_bf16 v[104:107], v[172:175], v[80:83], v[32:35]
    ds_read_b64_tr_b16 v[224:225], v25 offset:0
    ds_read_b64_tr_b16 v[226:227], v25 offset:0
    ds_read_b64_tr_b16 v[228:229], v26 offset:0
    ds_read_b64_tr_b16 v[230:231], v26 offset:128
    ds_read_b64_tr_b16 v[232:233], v27 offset:128
    ds_read_b64_tr_b16 v[234:235], v27 offset:256
    ds_read_b64_tr_b16 v[236:237], v28 offset:256
    ds_read_b64_tr_b16 v[238:239], v28 offset:384
    ds_read_b64_tr_b16 v[196:197], v25 offset:384
    ds_read_b64_tr_b16 v[198:199], v25 offset:512
    ds_read_b64 v[58:59], v56
    v_max_f32 v88, v88, v112
    v_max_f32 v92, v92, v116
    v_max_f32 v96, v96, v120
    v_max_f32 v89, v89, v113
    v_max_f32 v93, v93, v117
    v_max_f32 v97, v97, v121
    v_cvt_pk_bf16_f32 v84, v84, v85
    v_cvt_pk_bf16_f32 v85, v86, v87
    v_cvt_pk_bf16_f32 v180, v108, v109
    v_cvt_pk_bf16_f32 v181, v110, v111
    v_cvt_pk_bf16_f32 v220, v132, v133
    v_cvt_pk_bf16_f32 v221, v134, v135
    v_cvt_pk_bf16_f32 v156, v156, v157
    v_cvt_pk_bf16_f32 v157, v158, v159
    v_and_b32 v86, v156, v30
    v_and_b32 v87, v157, v30
    v_permlane16_swap_b32 v156, v182
    v_permlane16_swap_b32 v157, v183
    ds_write_b64 v24, v[156:157] offset:640
    s_nop 0
    v_mfma_f32_16x16x32_bf16 v[132:135], v[180:183], v[84:87], v[36:39]
    v_mfma_f32_16x16x32_bf16 v[108:111], v[176:179], v[84:87], v[32:35]
    ds_read_b64_tr_b16 v[200:201], v26 offset:512
    ds_read_b64_tr_b16 v[202:203], v26 offset:640
    v_max_f32 v90, v90, v114
    v_max_f32 v94, v94, v118
    v_max_f32 v98, v98, v122
    v_max_f32 v91, v91, v115
    v_max_f32 v95, v95, v119
    v_max_f32 v99, v99, v123
    v_max3_f32 v184, v88, v89, v90
    v_max3_f32 v186, v92, v93, v94
    v_max3_f32 v188, v96, v97, v98
    v_max_f32 v184, v184, v91
    v_max_f32 v186, v186, v95
    v_max_f32 v188, v188, v99
    v_mov_b32 v189, v188
    v_max_f32 v100, v100, v124
    v_max_f32 v104, v104, v128
    v_permlane32_swap_b32 v184, v186
    v_max_f32 v108, v108, v132
    v_max_f32 v101, v101, v125
    v_permlane32_swap_b32 v188, v189
    v_max_f32 v105, v105, v129
    v_max_f32 v109, v109, v133
    v_max_f32 v184, v184, v186
    v_max_f32 v102, v102, v126
    v_max_f32 v106, v106, v130
    v_max_f32 v188, v188, v189
    v_max_f32 v110, v110, v134
    v_max_f32 v103, v103, v127
    v_permlane16_swap_b32 v184, v188
    v_max_f32 v107, v107, v131
    v_max_f32 v111, v111, v135
    v_max_f32 v184, v184, v188
    v_max3_f32 v190, v100, v101, v102
    v_max3_f32 v192, v104, v105, v106
    v_mul_f32 v184, s40, v184
    v_max3_f32 v194, v108, v109, v110
    v_max_f32 v190, v190, v103
    v_mov_b32 v188, v184
    v_max_f32 v192, v192, v107
    v_max_f32 v194, v194, v111
    v_permlane16_swap_b32 v184, v188
    v_mov_b32 v186, v184
    s_nop 1
    v_permlane32_swap_b32 v184, v186
    v_mov_b32 v195, v194
    v_pk_fma_f32 v[88:89], v[88:89], s[40:41], v[184:185] op_sel_hi:[1,0,0] neg_lo:[0,0,1] neg_hi:[0,0,1]
    v_pk_fma_f32 v[92:93], v[92:93], s[40:41], v[186:187] op_sel_hi:[1,0,0] neg_lo:[0,0,1] neg_hi:[0,0,1]
    v_pk_fma_f32 v[96:97], v[96:97], s[40:41], v[188:189] op_sel_hi:[1,0,0] neg_lo:[0,0,1] neg_hi:[0,0,1]
    v_permlane32_swap_b32 v190, v192
    v_pk_fma_f32 v[90:91], v[90:91], s[40:41], v[184:185] op_sel_hi:[1,0,0] neg_lo:[0,0,1] neg_hi:[0,0,1]
    v_pk_fma_f32 v[94:95], v[94:95], s[40:41], v[186:187] op_sel_hi:[1,0,0] neg_lo:[0,0,1] neg_hi:[0,0,1]
    v_pk_fma_f32 v[98:99], v[98:99], s[40:41], v[188:189] op_sel_hi:[1,0,0] neg_lo:[0,0,1] neg_hi:[0,0,1]
    v_permlane32_swap_b32 v194, v195
    v_exp_f32 v88, v88
    v_exp_f32 v92, v92
    v_exp_f32 v96, v96
    v_max_f32 v190, v190, v192
    v_exp_f32 v89, v89
    v_exp_f32 v93, v93
    v_exp_f32 v97, v97
    v_max_f32 v194, v194, v195
    v_exp_f32 v90, v90
    v_exp_f32 v94, v94
    v_exp_f32 v98, v98
    v_permlane16_swap_b32 v190, v194
    v_exp_f32 v91, v91
    v_exp_f32 v95, v95
    v_exp_f32 v99, v99
    v_max_f32 v190, v190, v194
    v_cvt_pk_bf16_f32 v138, v88, v89
    v_cvt_pk_bf16_f32 v142, v92, v93
    v_cvt_pk_bf16_f32 v146, v96, v97
    v_mul_f32 v190, s40, v190
    v_cvt_pk_bf16_f32 v139, v90, v91
    v_cvt_pk_bf16_f32 v143, v94, v95
    v_cvt_pk_bf16_f32 v147, v98, v99
    v_mov_b32 v194, v190
    v_and_b32 v136, v138, v54
    v_and_b32 v140, v142, v54
    v_and_b32 v144, v146, v54
    v_permlane16_swap_b32 v190, v194
    v_and_b32 v137, v139, v55
    v_and_b32 v141, v143, v55
    v_and_b32 v145, v147, v55
    v_mov_b32 v192, v190
    v_xor_b32 v138, v138, v136
    v_xor_b32 v142, v142, v140
    v_xor_b32 v146, v146, v144
    v_permlane32_swap_b32 v190, v192
    v_xor_b32 v139, v139, v137
    v_xor_b32 v143, v143, v141
    v_xor_b32 v147, v147, v145
    s_waitcnt lgkmcnt(0)
    v_mfma_f32_16x16x32_bf16 v[112:115], v[44:47], v[136:139], 0
    v_pk_fma_f32 v[100:101], v[100:101], s[40:41], v[190:191] op_sel_hi:[1,0,0] neg_lo:[0,0,1] neg_hi:[0,0,1]
    v_pk_fma_f32 v[104:105], v[104:105], s[40:41], v[192:193] op_sel_hi:[1,0,0] neg_lo:[0,0,1] neg_hi:[0,0,1]
    v_mfma_f32_16x16x32_bf16 v[64:67], v[208:211], v[136:139], 0
    v_pk_fma_f32 v[108:109], v[108:109], s[40:41], v[194:195] op_sel_hi:[1,0,0] neg_lo:[0,0,1] neg_hi:[0,0,1]
    v_pk_fma_f32 v[102:103], v[102:103], s[40:41], v[190:191] op_sel_hi:[1,0,0] neg_lo:[0,0,1] neg_hi:[0,0,1]
    v_mfma_f32_16x16x32_bf16 v[240:243], v[224:227], v[136:139], 0
    v_pk_fma_f32 v[106:107], v[106:107], s[40:41], v[192:193] op_sel_hi:[1,0,0] neg_lo:[0,0,1] neg_hi:[0,0,1]
    v_pk_fma_f32 v[110:111], v[110:111], s[40:41], v[194:195] op_sel_hi:[1,0,0] neg_lo:[0,0,1] neg_hi:[0,0,1]
    v_mfma_f32_16x16x32_bf16 v[116:119], v[44:47], v[140:143], 0
    v_exp_f32 v100, v100
    v_exp_f32 v104, v104
    v_mfma_f32_16x16x32_bf16 v[68:71], v[210:213], v[140:143], 0
    v_exp_f32 v108, v108
    v_exp_f32 v101, v101
    v_mfma_f32_16x16x32_bf16 v[240:243], v[228:231], v[140:143], v[240:243]
    v_exp_f32 v105, v105
    v_exp_f32 v109, v109
    v_mfma_f32_16x16x32_bf16 v[120:123], v[44:47], v[144:147], 0
    v_exp_f32 v102, v102
    v_exp_f32 v106, v106
    v_mfma_f32_16x16x32_bf16 v[72:75], v[212:215], v[144:147], 0
    v_exp_f32 v110, v110
    v_exp_f32 v103, v103
    v_mfma_f32_16x16x32_bf16 v[240:243], v[232:235], v[144:147], v[240:243]
    v_exp_f32 v107, v107
    v_exp_f32 v111, v111
    v_readfirstlane_b32 s10, v58
    v_mov_b32 v252, v59
    v_xor_b32 v253, 0x5bd1e995, v59
    v_cvt_pk_bf16_f32 v150, v100, v101
    v_cvt_pk_bf16_f32 v154, v104, v105
    v_cvt_pk_bf16_f32 v158, v108, v109
    v_cvt_pk_bf16_f32 v151, v102, v103
    v_cvt_pk_bf16_f32 v155, v106, v107
    v_cvt_pk_bf16_f32 v159, v110, v111
    v_and_b32 v148, v150, v54
    v_and_b32 v152, v154, v54
    v_and_b32 v156, v158, v54
    v_and_b32 v149, v151, v55
    v_and_b32 v153, v155, v55
    v_and_b32 v157, v159, v55
    v_xor_b32 v150, v150, v148
    v_xor_b32 v154, v154, v152
    v_xor_b32 v158, v158, v156
    v_xor_b32 v151, v151, v149
    v_xor_b32 v155, v155, v153
    v_xor_b32 v159, v159, v157
    v_mfma_f32_16x16x32_bf16 v[124:127], v[44:47], v[148:151], 0
    v_rcp_f32 v184, v112
    v_rcp_f32 v186, v116
    v_mfma_f32_16x16x32_bf16 v[76:79], v[214:217], v[148:151], 0
    v_rcp_f32 v188, v120
    v_pk_mul_f32 v[64:65], v[64:65], v[184:185] op_sel_hi:[1,0]
    v_mfma_f32_16x16x32_bf16 v[240:243], v[236:239], v[148:151], v[240:243]
    v_pk_mul_f32 v[68:69], v[68:69], v[186:187] op_sel_hi:[1,0]
    v_pk_mul_f32 v[72:73], v[72:73], v[188:189] op_sel_hi:[1,0]
    v_mfma_f32_16x16x32_bf16 v[128:131], v[44:47], v[152:155], 0
    v_pk_mul_f32 v[66:67], v[66:67], v[184:185] op_sel_hi:[1,0]
    v_pk_mul_f32 v[70:71], v[70:71], v[186:187] op_sel_hi:[1,0]
    v_mfma_f32_16x16x32_bf16 v[80:83], v[216:219], v[152:155], 0
    v_pk_mul_f32 v[74:75], v[74:75], v[188:189] op_sel_hi:[1,0]
    v_cvt_pk_bf16_f32 v64, v64, v65
    v_mfma_f32_16x16x32_bf16 v[244:247], v[196:199], v[152:155], 0
    v_cvt_pk_bf16_f32 v68, v68, v69
    v_cvt_pk_bf16_f32 v72, v72, v73
    v_mfma_f32_16x16x32_bf16 v[132:135], v[44:47], v[156:159], 0
    v_cvt_pk_bf16_f32 v65, v66, v67
    v_cvt_pk_bf16_f32 v69, v70, v71
    v_mfma_f32_16x16x32_bf16 v[84:87], v[218:221], v[156:159], 0
    v_cvt_pk_bf16_f32 v73, v74, v75
    ds_write_b64 v48, v[64:65] offset:0
    v_mfma_f32_16x16x32_bf16 v[244:247], v[200:203], v[156:159], v[244:247]
    ds_write_b64 v48, v[68:69] offset:128
    ds_write_b64 v48, v[72:73] offset:256
    v_rcp_f32 v190, v124
    v_rcp_f32 v192, v128
    v_rcp_f32 v194, v132
    v_cndmask_b32_e64 v184, v184, v186, s[44:45]
    v_cndmask_b32_e64 v184, v184, v188, s[46:47]
    v_cndmask_b32_e64 v184, v184, v190, s[48:49]
    v_cndmask_b32_e64 v186, v192, v194, s[44:45]
    v_pk_mul_f32 v[76:77], v[76:77], v[190:191] op_sel_hi:[1,0]
    v_pk_mul_f32 v[80:81], v[80:81], v[192:193] op_sel_hi:[1,0]
    v_pk_mul_f32 v[84:85], v[84:85], v[194:195] op_sel_hi:[1,0]
    v_pk_mul_f32 v[78:79], v[78:79], v[190:191] op_sel_hi:[1,0]
    v_pk_mul_f32 v[82:83], v[82:83], v[192:193] op_sel_hi:[1,0]
    v_pk_mul_f32 v[86:87], v[86:87], v[194:195] op_sel_hi:[1,0]
    v_cvt_pk_bf16_f32 v76, v76, v77
    v_cvt_pk_bf16_f32 v80, v80, v81
    v_cvt_pk_bf16_f32 v84, v84, v85
    v_cvt_pk_bf16_f32 v77, v78, v79
    v_cvt_pk_bf16_f32 v81, v82, v83
    v_cvt_pk_bf16_f32 v85, v86, v87
    ds_write_b64 v48, v[76:77] offset:384
    ds_write_b64 v48, v[80:81] offset:512
    ds_write_b64 v48, v[84:85] offset:640
    v_pk_mul_f32 v[240:241], v[240:241], v[184:185] op_sel_hi:[1,0]
    v_pk_mul_f32 v[244:245], v[244:245], v[186:187] op_sel_hi:[1,0]
    v_pk_mul_f32 v[242:243], v[242:243], v[184:185] op_sel_hi:[1,0]
    v_pk_mul_f32 v[246:247], v[246:247], v[186:187] op_sel_hi:[1,0]
    v_cvt_pk_bf16_f32 v240, v240, v241
    v_cvt_pk_bf16_f32 v244, v244, v245
    v_cvt_pk_bf16_f32 v241, v242, v243
    v_cvt_pk_bf16_f32 v245, v246, v247
    ds_write_b64 v49, v[240:241] offset:0
    ds_write_b64 v23, v[244:245] offset:0
    s_cmp_eq_u32 s10, 1
    s_waitcnt lgkmcnt(0)
    s_barrier
    ds_read2_b64 v[64:67], v50 offset1:96
    ds_read2_b64 v[68:71], v53 offset1:96
    s_cbranch_scc1 B1P_NEAR
B1P_FAR:
    s_waitcnt lgkmcnt(1)
    buffer_store_dwordx4 v[64:67], v51, s[32:35], s38 offen sc1
    s_waitcnt lgkmcnt(0)
    buffer_store_dwordx4 v[68:71], v52, s[32:35], s38 offen sc1
    s_branch B2
B1P_NEAR:
    s_waitcnt lgkmcnt(1)
    buffer_store_dwordx4 v[64:67], v51, s[32:35], s38 offen nt
    s_waitcnt lgkmcnt(0)
    buffer_store_dwordx4 v[68:71], v52, s[32:35], s38 offen nt
B2:
    s_cmp_ge_u32 s59, 4
    s_cbranch_scc1 B2_GO
    s_waitcnt vmcnt(0)
    s_barrier
    s_endpgm
B2_GO:
    s_waitcnt vmcnt(0)
    s_barrier
    ds_read_b64_tr_b16 v[208:209], v7 offset:0
    ds_read_b64_tr_b16 v[210:211], v7 offset:512
    ds_read_b64_tr_b16 v[212:213], v8 offset:0
    ds_read_b64_tr_b16 v[214:215], v8 offset:512
    ds_read_b64_tr_b16 v[216:217], v7 offset:2048
    ds_read_b64_tr_b16 v[218:219], v7 offset:2560
    ds_read_b64_tr_b16 v[220:221], v8 offset:2048
    ds_read_b64_tr_b16 v[222:223], v8 offset:2560
    ds_read_b64_tr_b16 v[224:225], v7 offset:4096
    ds_read_b64_tr_b16 v[226:227], v7 offset:4608
    ds_read_b64_tr_b16 v[228:229], v8 offset:4096
    ds_read_b64_tr_b16 v[230:231], v8 offset:4608
    ds_read_b64_tr_b16 v[232:233], v7 offset:6144
    ds_read_b64_tr_b16 v[234:235], v7 offset:6656
    ds_read_b64_tr_b16 v[236:237], v8 offset:6144
    ds_read_b64_tr_b16 v[238:239], v8 offset:6656
    s_cmp_lg_u32 s10, 1
    s_cbranch_scc1 B2_WIDE
    v_lshrrev_b32 v3, 3, v3
    s_mov_b32 s8, 5257216
B2_WIDE:
    s_mov_b32 s4, 0
    s_mov_b64 exec, 0xffff
B2_POLL:
    buffer_load_dwordx2 v[250:251], v3, s[32:35], s8 offen sc1
    s_waitcnt vmcnt(0)
    v_cmp_ne_u32 vcc, v250, v252
    v_cmp_ne_u32 s[6:7], v251, v253
    s_nop 0
    s_or_b64 vcc, vcc, s[6:7]
    s_cbranch_vccz B2_GOT
    s_add_u32 s4, s4, 1
    s_cmp_lt_u32 s4, 0x40000
    s_cbranch_scc1 B2_POLL
B2_GOT:
    s_mov_b64 exec, -1
    buffer_load_dwordx4 v[48:51], v2, s[32:35], s20 offen offset:0 sc1
    buffer_load_dwordx4 v[52:55], v2, s[32:35], s20 offen offset:1024 sc1
    buffer_load_dwordx4 v[56:59], v2, s[32:35], s20 offen offset:2048 sc1
    buffer_load_dwordx4 v[60:63], v2, s[32:35], s20 offen offset:3072 sc1
    s_add_u32 s20, s20, 4096
    buffer_load_dwordx4 v[64:67], v2, s[32:35], s20 offen offset:0 sc1
    buffer_load_dwordx4 v[68:71], v2, s[32:35], s20 offen offset:1024 sc1
    buffer_load_dwordx4 v[72:75], v2, s[32:35], s20 offen offset:2048 sc1
    buffer_load_dwordx4 v[76:79], v2, s[32:35], s20 offen offset:3072 sc1
    s_add_u32 s20, s20, 4096
    s_waitcnt vmcnt(4)
    s_waitcnt lgkmcnt(12)
    v_mfma_f32_32x32x16_bf16 v[16:31], v[208:211], v[48:51], 0
    ds_read_b64_tr_b16 v[208:209], v7 offset:8192
    ds_read_b64_tr_b16 v[210:211], v7 offset:8704
    v_mfma_f32_32x32x16_bf16 v[32:47], v[212:215], v[48:51], 0
    ds_read_b64_tr_b16 v[212:213], v8 offset:8192
    ds_read_b64_tr_b16 v[214:215], v8 offset:8704
    buffer_load_dwordx4 v[80:83], v2, s[32:35], s20 offen offset:0 sc1
    s_waitcnt lgkmcnt(12)
    v_mfma_f32_32x32x16_bf16 v[16:31], v[216:219], v[52:55], v[16:31]
    ds_read_b64_tr_b16 v[216:217], v7 offset:10240
    ds_read_b64_tr_b16 v[218:219], v7 offset:10752
    v_mfma_f32_32x32x16_bf16 v[32:47], v[220:223], v[52:55], v[32:47]
    ds_read_b64_tr_b16 v[220:221], v8 offset:10240
    ds_read_b64_tr_b16 v[222:223], v8 offset:10752
    buffer_load_dwordx4 v[84:87], v2, s[32:35], s20 offen offset:1024 sc1
    s_waitcnt lgkmcnt(12)
    v_mfma_f32_32x32x16_bf16 v[16:31], v[224:227], v[56:59], v[16:31]
    ds_read_b64_tr_b16 v[224:225], v7 offset:12288
    ds_read_b64_tr_b16 v[226:227], v7 offset:12800
    v_mfma_f32_32x32x16_bf16 v[32:47], v[228:231], v[56:59], v[32:47]
    ds_read_b64_tr_b16 v[228:229], v8 offset:12288
    ds_read_b64_tr_b16 v[230:231], v8 offset:12800
    buffer_load_dwordx4 v[88:91], v2, s[32:35], s20 offen offset:2048 sc1
    s_waitcnt lgkmcnt(12)
    v_mfma_f32_32x32x16_bf16 v[16:31], v[232:235], v[60:63], v[16:31]
    ds_read_b64_tr_b16 v[232:233], v7 offset:14336
    ds_read_b64_tr_b16 v[234:235], v7 offset:14848
    v_mfma_f32_32x32x16_bf16 v[32:47], v[236:239], v[60:63], v[32:47]
    ds_read_b64_tr_b16 v[236:237], v8 offset:14336
    ds_read_b64_tr_b16 v[238:239], v8 offset:14848
    buffer_load_dwordx4 v[92:95], v2, s[32:35], s20 offen offset:3072 sc1
    s_add_u32 s20, s20, 4096
    s_waitcnt vmcnt(4)
    s_waitcnt lgkmcnt(12)
    v_mfma_f32_32x32x16_bf16 v[16:31], v[208:211], v[64:67], v[16:31]
    ds_read_b64_tr_b16 v[208:209], v7 offset:16384
    ds_read_b64_tr_b16 v[210:211], v7 offset:16896
    v_mfma_f32_32x32x16_bf16 v[32:47], v[212:215], v[64:67], v[32:47]
    ds_read_b64_tr_b16 v[212:213], v8 offset:16384
    ds_read_b64_tr_b16 v[214:215], v8 offset:16896
    buffer_load_dwordx4 v[96:99], v2, s[32:35], s20 offen offset:0 sc1
    s_waitcnt lgkmcnt(12)
    v_mfma_f32_32x32x16_bf16 v[16:31], v[216:219], v[68:71], v[16:31]
    ds_read_b64_tr_b16 v[216:217], v7 offset:18432
    ds_read_b64_tr_b16 v[218:219], v7 offset:18944
    v_mfma_f32_32x32x16_bf16 v[32:47], v[220:223], v[68:71], v[32:47]
    ds_read_b64_tr_b16 v[220:221], v8 offset:18432
    ds_read_b64_tr_b16 v[222:223], v8 offset:18944
    buffer_load_dwordx4 v[100:103], v2, s[32:35], s20 offen offset:1024 sc1
    s_waitcnt lgkmcnt(12)
    v_mfma_f32_32x32x16_bf16 v[16:31], v[224:227], v[72:75], v[16:31]
    ds_read_b64_tr_b16 v[224:225], v7 offset:20480
    ds_read_b64_tr_b16 v[226:227], v7 offset:20992
    v_mfma_f32_32x32x16_bf16 v[32:47], v[228:231], v[72:75], v[32:47]
    ds_read_b64_tr_b16 v[228:229], v8 offset:20480
    ds_read_b64_tr_b16 v[230:231], v8 offset:20992
    buffer_load_dwordx4 v[104:107], v2, s[32:35], s20 offen offset:2048 sc1
    s_waitcnt lgkmcnt(12)
    v_mfma_f32_32x32x16_bf16 v[16:31], v[232:235], v[76:79], v[16:31]
    ds_read_b64_tr_b16 v[232:233], v7 offset:22528
    ds_read_b64_tr_b16 v[234:235], v7 offset:23040
    v_mfma_f32_32x32x16_bf16 v[32:47], v[236:239], v[76:79], v[32:47]
    ds_read_b64_tr_b16 v[236:237], v8 offset:22528
    ds_read_b64_tr_b16 v[238:239], v8 offset:23040
    buffer_load_dwordx4 v[108:111], v2, s[32:35], s20 offen offset:3072 sc1
    s_add_u32 s20, s20, 4096
    s_waitcnt vmcnt(4)
    s_waitcnt lgkmcnt(12)
    v_mfma_f32_32x32x16_bf16 v[16:31], v[208:211], v[80:83], v[16:31]
    ds_read_b64_tr_b16 v[208:209], v7 offset:24576
    ds_read_b64_tr_b16 v[210:211], v7 offset:25088
    v_mfma_f32_32x32x16_bf16 v[32:47], v[212:215], v[80:83], v[32:47]
    ds_read_b64_tr_b16 v[212:213], v8 offset:24576
    ds_read_b64_tr_b16 v[214:215], v8 offset:25088
    buffer_load_dwordx4 v[112:115], v2, s[32:35], s20 offen offset:0 sc1
    s_waitcnt lgkmcnt(12)
    v_mfma_f32_32x32x16_bf16 v[16:31], v[216:219], v[84:87], v[16:31]
    ds_read_b64_tr_b16 v[216:217], v7 offset:26624
    ds_read_b64_tr_b16 v[218:219], v7 offset:27136
    v_mfma_f32_32x32x16_bf16 v[32:47], v[220:223], v[84:87], v[32:47]
    ds_read_b64_tr_b16 v[220:221], v8 offset:26624
    ds_read_b64_tr_b16 v[222:223], v8 offset:27136
    buffer_load_dwordx4 v[116:119], v2, s[32:35], s20 offen offset:1024 sc1
    s_waitcnt lgkmcnt(12)
    v_mfma_f32_32x32x16_bf16 v[16:31], v[224:227], v[88:91], v[16:31]
    ds_read_b64_tr_b16 v[224:225], v7 offset:28672
    ds_read_b64_tr_b16 v[226:227], v7 offset:29184
    v_mfma_f32_32x32x16_bf16 v[32:47], v[228:231], v[88:91], v[32:47]
    ds_read_b64_tr_b16 v[228:229], v8 offset:28672
    ds_read_b64_tr_b16 v[230:231], v8 offset:29184
    buffer_load_dwordx4 v[120:123], v2, s[32:35], s20 offen offset:2048 sc1
    s_waitcnt lgkmcnt(12)
    v_mfma_f32_32x32x16_bf16 v[16:31], v[232:235], v[92:95], v[16:31]
    ds_read_b64_tr_b16 v[232:233], v7 offset:30720
    ds_read_b64_tr_b16 v[234:235], v7 offset:31232
    v_mfma_f32_32x32x16_bf16 v[32:47], v[236:239], v[92:95], v[32:47]
    ds_read_b64_tr_b16 v[236:237], v8 offset:30720
    ds_read_b64_tr_b16 v[238:239], v8 offset:31232
    buffer_load_dwordx4 v[124:127], v2, s[32:35], s20 offen offset:3072 sc1
    s_add_u32 s20, s20, 4096
    s_waitcnt vmcnt(4)
    s_waitcnt lgkmcnt(12)
    v_mfma_f32_32x32x16_bf16 v[16:31], v[208:211], v[96:99], v[16:31]
    ds_read_b64_tr_b16 v[208:209], v7 offset:32768
    ds_read_b64_tr_b16 v[210:211], v7 offset:33280
    v_mfma_f32_32x32x16_bf16 v[32:47], v[212:215], v[96:99], v[32:47]
    ds_read_b64_tr_b16 v[212:213], v8 offset:32768
    ds_read_b64_tr_b16 v[214:215], v8 offset:33280
    buffer_load_dwordx4 v[128:131], v2, s[32:35], s20 offen offset:0 sc1
    s_waitcnt lgkmcnt(12)
    v_mfma_f32_32x32x16_bf16 v[16:31], v[216:219], v[100:103], v[16:31]
    ds_read_b64_tr_b16 v[216:217], v7 offset:34816
    ds_read_b64_tr_b16 v[218:219], v7 offset:35328
    v_mfma_f32_32x32x16_bf16 v[32:47], v[220:223], v[100:103], v[32:47]
    ds_read_b64_tr_b16 v[220:221], v8 offset:34816
    ds_read_b64_tr_b16 v[222:223], v8 offset:35328
    buffer_load_dwordx4 v[132:135], v2, s[32:35], s20 offen offset:1024 sc1
    s_waitcnt lgkmcnt(12)
    v_mfma_f32_32x32x16_bf16 v[16:31], v[224:227], v[104:107], v[16:31]
    ds_read_b64_tr_b16 v[224:225], v7 offset:36864
    ds_read_b64_tr_b16 v[226:227], v7 offset:37376
    v_mfma_f32_32x32x16_bf16 v[32:47], v[228:231], v[104:107], v[32:47]
    ds_read_b64_tr_b16 v[228:229], v8 offset:36864
    ds_read_b64_tr_b16 v[230:231], v8 offset:37376
    buffer_load_dwordx4 v[136:139], v2, s[32:35], s20 offen offset:2048 sc1
    s_waitcnt lgkmcnt(12)
    v_mfma_f32_32x32x16_bf16 v[16:31], v[232:235], v[108:111], v[16:31]
    ds_read_b64_tr_b16 v[232:233], v7 offset:38912
    ds_read_b64_tr_b16 v[234:235], v7 offset:39424
    v_mfma_f32_32x32x16_bf16 v[32:47], v[236:239], v[108:111], v[32:47]
    ds_read_b64_tr_b16 v[236:237], v8 offset:38912
    ds_read_b64_tr_b16 v[238:239], v8 offset:39424
    buffer_load_dwordx4 v[140:143], v2, s[32:35], s20 offen offset:3072 sc1
    s_add_u32 s20, s20, 4096
    s_waitcnt vmcnt(4)
    s_waitcnt lgkmcnt(12)
    v_mfma_f32_32x32x16_bf16 v[16:31], v[208:211], v[112:115], v[16:31]
    ds_read_b64_tr_b16 v[208:209], v7 offset:40960
    ds_read_b64_tr_b16 v[210:211], v7 offset:41472
    v_mfma_f32_32x32x16_bf16 v[32:47], v[212:215], v[112:115], v[32:47]
    ds_read_b64_tr_b16 v[212:213], v8 offset:40960
    ds_read_b64_tr_b16 v[214:215], v8 offset:41472
    buffer_load_dwordx4 v[144:147], v2, s[32:35], s20 offen offset:0 sc1
    s_waitcnt lgkmcnt(12)
    v_mfma_f32_32x32x16_bf16 v[16:31], v[216:219], v[116:119], v[16:31]
    ds_read_b64_tr_b16 v[216:217], v7 offset:43008
    ds_read_b64_tr_b16 v[218:219], v7 offset:43520
    v_mfma_f32_32x32x16_bf16 v[32:47], v[220:223], v[116:119], v[32:47]
    ds_read_b64_tr_b16 v[220:221], v8 offset:43008
    ds_read_b64_tr_b16 v[222:223], v8 offset:43520
    buffer_load_dwordx4 v[148:151], v2, s[32:35], s20 offen offset:1024 sc1
    s_waitcnt lgkmcnt(12)
    v_mfma_f32_32x32x16_bf16 v[16:31], v[224:227], v[120:123], v[16:31]
    ds_read_b64_tr_b16 v[224:225], v7 offset:45056
    ds_read_b64_tr_b16 v[226:227], v7 offset:45568
    v_mfma_f32_32x32x16_bf16 v[32:47], v[228:231], v[120:123], v[32:47]
    ds_read_b64_tr_b16 v[228:229], v8 offset:45056
    ds_read_b64_tr_b16 v[230:231], v8 offset:45568
    buffer_load_dwordx4 v[152:155], v2, s[32:35], s20 offen offset:2048 sc1
    s_waitcnt lgkmcnt(12)
    v_mfma_f32_32x32x16_bf16 v[16:31], v[232:235], v[124:127], v[16:31]
    ds_read_b64_tr_b16 v[232:233], v7 offset:47104
    ds_read_b64_tr_b16 v[234:235], v7 offset:47616
    v_mfma_f32_32x32x16_bf16 v[32:47], v[236:239], v[124:127], v[32:47]
    ds_read_b64_tr_b16 v[236:237], v8 offset:47104
    ds_read_b64_tr_b16 v[238:239], v8 offset:47616
    buffer_load_dwordx4 v[156:159], v2, s[32:35], s20 offen offset:3072 sc1
    s_add_u32 s20, s20, 4096
    s_waitcnt vmcnt(4)
    s_waitcnt lgkmcnt(12)
    v_mfma_f32_32x32x16_bf16 v[16:31], v[208:211], v[128:131], v[16:31]
    ds_read_b64_tr_b16 v[208:209], v7 offset:49152
    ds_read_b64_tr_b16 v[210:211], v7 offset:49664
    v_mfma_f32_32x32x16_bf16 v[32:47], v[212:215], v[128:131], v[32:47]
    ds_read_b64_tr_b16 v[212:213], v8 offset:49152
    ds_read_b64_tr_b16 v[214:215], v8 offset:49664
    buffer_load_dwordx4 v[160:163], v2, s[32:35], s20 offen offset:0 sc1
    s_waitcnt lgkmcnt(12)
    v_mfma_f32_32x32x16_bf16 v[16:31], v[216:219], v[132:135], v[16:31]
    ds_read_b64_tr_b16 v[216:217], v7 offset:51200
    ds_read_b64_tr_b16 v[218:219], v7 offset:51712
    v_mfma_f32_32x32x16_bf16 v[32:47], v[220:223], v[132:135], v[32:47]
    ds_read_b64_tr_b16 v[220:221], v8 offset:51200
    ds_read_b64_tr_b16 v[222:223], v8 offset:51712
    buffer_load_dwordx4 v[164:167], v2, s[32:35], s20 offen offset:1024 sc1
    s_waitcnt lgkmcnt(12)
    v_mfma_f32_32x32x16_bf16 v[16:31], v[224:227], v[136:139], v[16:31]
    ds_read_b64_tr_b16 v[224:225], v7 offset:53248
    ds_read_b64_tr_b16 v[226:227], v7 offset:53760
    v_mfma_f32_32x32x16_bf16 v[32:47], v[228:231], v[136:139], v[32:47]
    ds_read_b64_tr_b16 v[228:229], v8 offset:53248
    ds_read_b64_tr_b16 v[230:231], v8 offset:53760
    buffer_load_dwordx4 v[168:171], v2, s[32:35], s20 offen offset:2048 sc1
    s_waitcnt lgkmcnt(12)
    v_mfma_f32_32x32x16_bf16 v[16:31], v[232:235], v[140:143], v[16:31]
    ds_read_b64_tr_b16 v[232:233], v7 offset:55296
    ds_read_b64_tr_b16 v[234:235], v7 offset:55808
    v_mfma_f32_32x32x16_bf16 v[32:47], v[236:239], v[140:143], v[32:47]
    ds_read_b64_tr_b16 v[236:237], v8 offset:55296
    ds_read_b64_tr_b16 v[238:239], v8 offset:55808
    buffer_load_dwordx4 v[172:175], v2, s[32:35], s20 offen offset:3072 sc1
    s_add_u32 s20, s20, 4096
    s_waitcnt vmcnt(4)
    s_waitcnt lgkmcnt(12)
    v_mfma_f32_32x32x16_bf16 v[16:31], v[208:211], v[144:147], v[16:31]
    ds_read_b64_tr_b16 v[208:209], v7 offset:57344
    ds_read_b64_tr_b16 v[210:211], v7 offset:57856
    v_mfma_f32_32x32x16_bf16 v[32:47], v[212:215], v[144:147], v[32:47]
    ds_read_b64_tr_b16 v[212:213], v8 offset:57344
    ds_read_b64_tr_b16 v[214:215], v8 offset:57856
    buffer_load_dwordx4 v[176:179], v2, s[32:35], s20 offen offset:0 sc1
    s_waitcnt lgkmcnt(12)
    v_mfma_f32_32x32x16_bf16 v[16:31], v[216:219], v[148:151], v[16:31]
    ds_read_b64_tr_b16 v[216:217], v7 offset:59392
    ds_read_b64_tr_b16 v[218:219], v7 offset:59904
    v_mfma_f32_32x32x16_bf16 v[32:47], v[220:223], v[148:151], v[32:47]
    ds_read_b64_tr_b16 v[220:221], v8 offset:59392
    ds_read_b64_tr_b16 v[222:223], v8 offset:59904
    buffer_load_dwordx4 v[180:183], v2, s[32:35], s20 offen offset:1024 sc1
    s_waitcnt lgkmcnt(12)
    v_mfma_f32_32x32x16_bf16 v[16:31], v[224:227], v[152:155], v[16:31]
    ds_read_b64_tr_b16 v[224:225], v7 offset:61440
    ds_read_b64_tr_b16 v[226:227], v7 offset:61952
    v_mfma_f32_32x32x16_bf16 v[32:47], v[228:231], v[152:155], v[32:47]
    ds_read_b64_tr_b16 v[228:229], v8 offset:61440
    ds_read_b64_tr_b16 v[230:231], v8 offset:61952
    buffer_load_dwordx4 v[184:187], v2, s[32:35], s20 offen offset:2048 sc1
    s_waitcnt lgkmcnt(12)
    v_mfma_f32_32x32x16_bf16 v[16:31], v[232:235], v[156:159], v[16:31]
    ds_read_b64_tr_b16 v[232:233], v7 offset:63488
    ds_read_b64_tr_b16 v[234:235], v7 offset:64000
    v_mfma_f32_32x32x16_bf16 v[32:47], v[236:239], v[156:159], v[32:47]
    ds_read_b64_tr_b16 v[236:237], v8 offset:63488
    ds_read_b64_tr_b16 v[238:239], v8 offset:64000
    buffer_load_dwordx4 v[188:191], v2, s[32:35], s20 offen offset:3072 sc1
    s_add_u32 s20, s20, 4096
    s_waitcnt vmcnt(4)
    v_add_u32 v7, 0x10000, v7
    v_add_u32 v8, 0x10000, v8
    s_waitcnt lgkmcnt(12)
    v_mfma_f32_32x32x16_bf16 v[16:31], v[208:211], v[160:163], v[16:31]
    ds_read_b64_tr_b16 v[208:209], v7 offset:0
    ds_read_b64_tr_b16 v[210:211], v7 offset:512
    v_mfma_f32_32x32x16_bf16 v[32:47], v[212:215], v[160:163], v[32:47]
    ds_read_b64_tr_b16 v[212:213], v8 offset:0
    ds_read_b64_tr_b16 v[214:215], v8 offset:512
    buffer_load_dwordx4 v[192:195], v2, s[32:35], s20 offen offset:0 sc1
    s_waitcnt lgkmcnt(12)
    v_mfma_f32_32x32x16_bf16 v[16:31], v[216:219], v[164:167], v[16:31]
    ds_read_b64_tr_b16 v[216:217], v7 offset:2048
    ds_read_b64_tr_b16 v[218:219], v7 offset:2560
    v_mfma_f32_32x32x16_bf16 v[32:47], v[220:223], v[164:167], v[32:47]
    ds_read_b64_tr_b16 v[220:221], v8 offset:2048
    ds_read_b64_tr_b16 v[222:223], v8 offset:2560
    buffer_load_dwordx4 v[196:199], v2, s[32:35], s20 offen offset:1024 sc1
    s_waitcnt lgkmcnt(12)
    v_mfma_f32_32x32x16_bf16 v[16:31], v[224:227], v[168:171], v[16:31]
    ds_read_b64_tr_b16 v[224:225], v7 offset:4096
    ds_read_b64_tr_b16 v[226:227], v7 offset:4608
    v_mfma_f32_32x32x16_bf16 v[32:47], v[228:231], v[168:171], v[32:47]
    ds_read_b64_tr_b16 v[228:229], v8 offset:4096
    ds_read_b64_tr_b16 v[230:231], v8 offset:4608
    buffer_load_dwordx4 v[200:203], v2, s[32:35], s20 offen offset:2048 sc1
    s_waitcnt lgkmcnt(12)
    v_mfma_f32_32x32x16_bf16 v[16:31], v[232:235], v[172:175], v[16:31]
    ds_read_b64_tr_b16 v[232:233], v7 offset:6144
    ds_read_b64_tr_b16 v[234:235], v7 offset:6656
    v_mfma_f32_32x32x16_bf16 v[32:47], v[236:239], v[172:175], v[32:47]
    ds_read_b64_tr_b16 v[236:237], v8 offset:6144
    ds_read_b64_tr_b16 v[238:239], v8 offset:6656
    buffer_load_dwordx4 v[204:207], v2, s[32:35], s20 offen offset:3072 sc1
    s_add_u32 s20, s20, 4096
    s_waitcnt vmcnt(4)
    s_waitcnt lgkmcnt(12)
    v_mfma_f32_32x32x16_bf16 v[16:31], v[208:211], v[176:179], v[16:31]
    ds_read_b64_tr_b16 v[208:209], v7 offset:8192
    ds_read_b64_tr_b16 v[210:211], v7 offset:8704
    v_mfma_f32_32x32x16_bf16 v[32:47], v[212:215], v[176:179], v[32:47]
    ds_read_b64_tr_b16 v[212:213], v8 offset:8192
    ds_read_b64_tr_b16 v[214:215], v8 offset:8704
    s_waitcnt lgkmcnt(12)
    v_mfma_f32_32x32x16_bf16 v[16:31], v[216:219], v[180:183], v[16:31]
    ds_read_b64_tr_b16 v[216:217], v7 offset:10240
    ds_read_b64_tr_b16 v[218:219], v7 offset:10752
    v_mfma_f32_32x32x16_bf16 v[32:47], v[220:223], v[180:183], v[32:47]
    ds_read_b64_tr_b16 v[220:221], v8 offset:10240
    ds_read_b64_tr_b16 v[222:223], v8 offset:10752
    s_waitcnt lgkmcnt(12)
    v_mfma_f32_32x32x16_bf16 v[16:31], v[224:227], v[184:187], v[16:31]
    ds_read_b64_tr_b16 v[224:225], v7 offset:12288
    ds_read_b64_tr_b16 v[226:227], v7 offset:12800
    v_mfma_f32_32x32x16_bf16 v[32:47], v[228:231], v[184:187], v[32:47]
    ds_read_b64_tr_b16 v[228:229], v8 offset:12288
    ds_read_b64_tr_b16 v[230:231], v8 offset:12800
    s_waitcnt lgkmcnt(12)
    v_mfma_f32_32x32x16_bf16 v[16:31], v[232:235], v[188:191], v[16:31]
    ds_read_b64_tr_b16 v[232:233], v7 offset:14336
    ds_read_b64_tr_b16 v[234:235], v7 offset:14848
    v_mfma_f32_32x32x16_bf16 v[32:47], v[236:239], v[188:191], v[32:47]
    ds_read_b64_tr_b16 v[236:237], v8 offset:14336
    ds_read_b64_tr_b16 v[238:239], v8 offset:14848
    s_waitcnt vmcnt(0)
    s_waitcnt lgkmcnt(14)
    v_mfma_f32_32x32x16_bf16 v[16:31], v[208:211], v[192:195], v[16:31]
    s_waitcnt lgkmcnt(10)
    v_mfma_f32_32x32x16_bf16 v[16:31], v[216:219], v[196:199], v[16:31]
    s_waitcnt lgkmcnt(6)
    v_mfma_f32_32x32x16_bf16 v[16:31], v[224:227], v[200:203], v[16:31]
    s_waitcnt lgkmcnt(2)
    v_mfma_f32_32x32x16_bf16 v[16:31], v[232:235], v[204:207], v[16:31]
    s_waitcnt lgkmcnt(0)
    v_mfma_f32_32x32x16_bf16 v[32:47], v[212:215], v[192:195], v[32:47]
    v_mfma_f32_32x32x16_bf16 v[32:47], v[220:223], v[196:199], v[32:47]
    v_mfma_f32_32x32x16_bf16 v[32:47], v[228:231], v[200:203], v[32:47]
    v_mfma_f32_32x32x16_bf16 v[32:47], v[236:239], v[204:207], v[32:47]
    s_nop 6
    v_cvt_pk_bf16_f32 v64, v16, v17
    v_cvt_pk_bf16_f32 v65, v18, v19
    ds_write_b64 v9, v[64:65]
    v_cvt_pk_bf16_f32 v66, v20, v21
    v_cvt_pk_bf16_f32 v67, v22, v23
    v_xor_b32 v12, 16, v9
    ds_write_b64 v12, v[66:67]
    v_cvt_pk_bf16_f32 v68, v24, v25
    v_cvt_pk_bf16_f32 v69, v26, v27
    v_xor_b32 v12, 32, v9
    ds_write_b64 v12, v[68:69]
    v_cvt_pk_bf16_f32 v70, v28, v29
    v_cvt_pk_bf16_f32 v71, v30, v31
    v_xor_b32 v12, 48, v9
    ds_write_b64 v12, v[70:71]
    v_cvt_pk_bf16_f32 v72, v32, v33
    v_cvt_pk_bf16_f32 v73, v34, v35
    v_xor_b32 v12, 64, v9
    ds_write_b64 v12, v[72:73]
    v_cvt_pk_bf16_f32 v74, v36, v37
    v_cvt_pk_bf16_f32 v75, v38, v39
    v_xor_b32 v12, 80, v9
    ds_write_b64 v12, v[74:75]
    v_cvt_pk_bf16_f32 v76, v40, v41
    v_cvt_pk_bf16_f32 v77, v42, v43
    v_xor_b32 v12, 96, v9
    ds_write_b64 v12, v[76:77]
    v_cvt_pk_bf16_f32 v78, v44, v45
    v_cvt_pk_bf16_f32 v79, v46, v47
    v_xor_b32 v12, 112, v9
    ds_write_b64 v12, v[78:79]
    ds_read_b128 v[96:99], v10 offset:0
    ds_read_b128 v[100:103], v10 offset:1024
    ds_read_b128 v[104:107], v10 offset:2048
    ds_read_b128 v[108:111], v10 offset:3072
    s_waitcnt lgkmcnt(3)
    buffer_store_dwordx4 v[96:99], v11, s[24:27], s37 offen nt
    s_add_u32 s37, s37, 40960
    s_waitcnt lgkmcnt(2)
    buffer_store_dwordx4 v[100:103], v11, s[24:27], s37 offen nt
    s_add_u32 s37, s37, 40960
    s_waitcnt lgkmcnt(1)
    buffer_store_dwordx4 v[104:107], v11, s[24:27], s37 offen nt
    s_add_u32 s37, s37, 40960
    s_waitcnt lgkmcnt(0)
    buffer_store_dwordx4 v[108:111], v11, s[24:27], s37 offen nt
    s_endpgm
A1:
    s_sub_u32 s18, s59, 24
    s_lshr_b32 s19, s18, 2
    s_lshl_b32 s17, s58, 1
    s_add_u32 s17, s17, s19
    s_and_b32 s18, s18, 3
    s_mul_i32 s47, s18, 3
    s_min_u32 s47, s47, 8
    s_and_b32 s19, s16, 3
    v_lshrrev_b32 v3, 4, v0
    s_mov_b32 s48, 0x05040100
    s_mov_b32 s49, 0x07060302
    s_cmp_lt_u32 s16, 4
    s_cbranch_scc1 A1_PROD
    s_setprio 3
    v_lshrrev_b32 v2, 3, v0
    v_and_b32 v4, 7, v0
    s_mul_i32 s24, s17, 5120
    s_mul_i32 s25, s19, 655360
    s_add_u32 s24, s24, s25
    v_mul_u32_u24 v5, 1280, v3
    v_add_u32 v5, s24, v5
    v_and_b32 v6, 15, v0
    s_lshl_b32 s24, s19, 3
    s_and_b32 s24, s24, 8
    v_xor_b32 v6, s24, v6
    v_lshl_add_u32 v26, v6, 4, v5
    v_xor_b32 v6, 16, v26
    v_add_u32 v27, 81920, v6
    v_xor_b32 v6, 32, v26
    v_add_u32 v28, 163840, v6
    v_xor_b32 v6, 48, v26
    v_add_u32 v29, 245760, v6
    v_xor_b32 v6, 64, v26
    v_add_u32 v30, 327680, v6
    v_xor_b32 v6, 80, v26
    v_add_u32 v31, 409600, v6
    v_xor_b32 v6, 96, v26
    v_add_u32 v32, 491520, v6
    v_xor_b32 v6, 112, v26
    v_add_u32 v33, 573440, v6
    v_mul_u32_u24 v5, 2560, v2
    v_xor_b32 v6, v3, v4
    v_lshl_add_u32 v14, v6, 4, v5
    s_lshr_b32 s24, s19, 1
    s_lshl_b32 s25, s24, 6
    v_xor_b32 v14, s25, v14
    s_lshl_b32 s25, s47, 1
    s_add_u32 s25, s25, s24
    s_mul_i32 s25, s25, 20480
    v_add_u32 v14, s25, v14
    v_add_u32 v15, 40960, v14
    v_add_u32 v16, 81920, v14
    s_and_b32 s41, s19, 1
    s_lshl_b32 s41, s41, 1
    s_add_u32 s41, s41, s24
    s_lshl_b32 s41, s41, 10
    s_add_u32 s41, s41, 32768
    s_lshl_b32 s40, s19, 13
    s_mul_i32 s37, s18, 0
    s_mul_i32 s38, s18, 0
    s_mov_b32 s43, 0
    s_mov_b32 s42, -2
    s_cmp_lt_u32 s18, 2
    s_cselect_b64 vcc, -1, 0
    s_lshl_b32 s24, s18, 2
    s_add_u32 s24, s24, s19
    s_cmp_eq_u32 s24, 1
    s_cselect_b32 s46, 1, 0
    v_lshlrev_b32 v8, 2, v0
    v_add_u32 v8, 34816, v8
    v_mov_b32 v9, 0xbf803f80
    v_lshlrev_b32 v250, 7, v0
    s_sub_u32 s56, s59, 24
    s_lshl_b32 s56, s56, 2
    s_add_u32 s56, s56, s19
    s_bitcmp1_b32 s16, 0
    s_waitcnt lgkmcnt(0)
    s_cselect_b32 s28, s68, s66
    s_cselect_b32 s29, s69, s67
    s_mov_b32 s30, 819200
    s_mov_b32 s31, 0x20000
    s_mov_b32 s20, s60
    s_mov_b32 s21, s61
    s_mov_b32 s22, 2621440
    s_mov_b32 s23, 0x20000
    s_mov_b32 s4, s72
    s_mov_b32 s5, s73
    s_mov_b32 s6, 2457600
    s_mov_b32 s7, 0x20000
    s_lshl_b32 s8, s58, 5
    s_add_u32 s8, s8, s56
    s_mul_i32 s8, s8, 2048
    s_add_u32 s8, s8, 1933312
    s_mov_b32 exec_lo, 0xffff
    s_mov_b32 exec_hi, 0x0
    buffer_load_dword v251, v250, s[4:7], s8 offen
    s_mov_b64 exec, -1
A1_LLOOP:
    s_add_u32 m0, s40, 0
    s_nop 0
    buffer_load_dwordx4 v26, s[20:23], s37 offen lds
    s_add_u32 m0, s41, 0
    s_nop 0
    buffer_load_dwordx4 v14, s[28:31], s38 offen lds
    s_add_u32 m0, s40, 1024
    s_nop 0
    buffer_load_dwordx4 v27, s[20:23], s37 offen lds
    s_add_u32 m0, s40, 2048
    s_nop 0
    buffer_load_dwordx4 v28, s[20:23], s37 offen lds
    s_add_u32 m0, s41, 4096
    s_nop 0
    buffer_load_dwordx4 v15, s[28:31], s38 offen lds
    s_add_u32 m0, s40, 3072
    s_nop 0
    buffer_load_dwordx4 v29, s[20:23], s37 offen lds
    s_add_u32 m0, s40, 4096
    s_nop 0
    buffer_load_dwordx4 v30, s[20:23], s37 offen lds
    s_cbranch_vccz A1_SK
    s_add_u32 m0, s41, 8192
    s_nop 0
    buffer_load_dwordx4 v16, s[28:31], s38 offen lds
A1_SK:
    s_add_u32 m0, s40, 5120
    s_nop 0
    buffer_load_dwordx4 v31, s[20:23], s37 offen lds
    s_add_u32 m0, s40, 6144
    s_nop 0
    buffer_load_dwordx4 v32, s[20:23], s37 offen lds
    s_add_u32 m0, s40, 7168
    s_nop 0
    buffer_load_dwordx4 v33, s[20:23], s37 offen lds
    s_cmp_eq_u32 s42, 0
    s_cselect_b32 s24, -106496, 0
    s_cmp_lg_u32 s42, 0
    s_cselect_b32 s24, 53248, s24
    s_add_u32 s40, s40, s24
    s_add_u32 s41, s41, s24
    s_add_u32 s38, s38, 128
    s_cmp_eq_u32 s38, 640
    s_cselect_b32 s38, 0, s38
    s_lshl_b32 s37, s38, 1
    s_add_u32 s42, s42, 1
    s_cmp_lg_u32 s42, -1
    s_cbranch_scc1 A1_LGO
    s_branch A1_LLOOP
A1_LGO:
    s_waitcnt vmcnt(10)
    s_cmp_eq_u32 s46, 0
    s_cbranch_scc1 A1_NOFIX1
    v_add_u32 v25, s43, v8
    s_mov_b32 exec_hi, 0
    ds_write_b32 v25, v9
    s_mov_b32 exec_hi, -1
    s_waitcnt lgkmcnt(0)
A1_NOFIX1:
    s_barrier
    s_add_u32 s43, s43, 53248
    s_cmp_eq_u32 s43, 159744
    s_cselect_b32 s43, 0, s43
    s_cmp_lg_u32 s42, 0
    s_cbranch_scc1 A1_NONONCE
    s_lshl_b32 s24, s2, 3
    s_add_u32 s24, s24, s16
    s_cmp_lg_u32 s24, 2047
    s_cbranch_scc1 A1_NONONCE
    s_mov_b32 s32, s80
    s_mov_b32 s33, s81
    s_mov_b32 s34, 5312512
    s_mov_b32 s35, 0x20000
    s_mov_b32 s52, s78
    s_mov_b32 s53, s79
    s_mov_b32 s54, 256
    s_mov_b32 s55, 0x20000
    v_mov_b32 v6, 0
    s_mov_b32 s24, 5308416
    s_mov_b64 exec, 1
    buffer_load_dword v7, v6, s[32:35], s24 offen sc1
    s_waitcnt vmcnt(0)
    v_add_u32 v7, 2, v7
    v_or_b32 v7, 1, v7
    buffer_store_dword v7, v6, s[52:55], 0 offen sc1
    buffer_store_dword v7, v6, s[32:35], s24 offen sc1
    s_mov_b64 exec, -1
A1_NONONCE:
    s_cmp_lt_u32 s42, 3
    s_cbranch_scc1 A1_LLOOP
    s_mov_b32 s52, s78
    s_mov_b32 s53, s79
    s_mov_b32 s54, 256
    s_mov_b32 s55, 0x20000
    v_mov_b32 v255, 0
    buffer_load_dword v252, v255, s[52:55], 0 offen sc1
    s_waitcnt vmcnt(0)
    s_cmp_eq_u32 s46, 0
    s_cbranch_scc1 A1_NOFIX2
    v_add_u32 v25, s43, v8
    s_mov_b32 exec_hi, 0
    ds_write_b32 v25, v9
    s_mov_b32 exec_hi, -1
    s_waitcnt lgkmcnt(0)
A1_NOFIX2:
    s_barrier
    s_cmp_lg_u32 s16, 6
    s_cbranch_scc1 A1_NOTAG
    s_mov_b32 s10, 0
A1_NONCE:
    v_readfirstlane_b32 s11, v252
    s_nop 0
    s_cmp_lg_u32 s11, 0
    s_cbranch_scc1 A1_TAG
    s_add_u32 s10, s10, 1
    s_cmp_gt_u32 s10, 0x40000
    s_cbranch_scc1 A1_TAG
    buffer_load_dword v252, v255, s[52:55], 0 offen sc1
    s_waitcnt vmcnt(0)
    s_branch A1_NONCE
A1_TAG:
    v_xor_b32 v253, 0x5bd1e995, v252
    v_mov_b32 v6, 163824
    ds_write_b32 v6, v252
A1_NOTAG:
    s_mul_i32 s57, s56, 7680
    s_mov_b32 exec_hi, 0xfffffff
    s_add_u32 s50, s58, 8
    s_cmp_ge_u32 s50, 10
    s_cselect_b32 s51, 10, 0
    s_sub_u32 s50, s50, s51
    s_mul_i32 s50, s50, 245760
    s_add_u32 s50, s50, s57
    buffer_load_dword v251, v250, s[4:7], s50 offen
    s_add_u32 s50, s58, 9
    s_cmp_ge_u32 s50, 10
    s_cselect_b32 s51, 10, 0
    s_sub_u32 s50, s50, s51
    s_mul_i32 s50, s50, 245760
    s_add_u32 s50, s50, s57
    buffer_load_dword v251, v250, s[4:7], s50 offen
    s_mov_b32 exec_hi, -1
    s_mov_b32 s32, s80
    s_mov_b32 s33, s81
    s_mov_b32 s34, 5312512
    s_mov_b32 s35, 0x20000
    v_and_b32 v2, 15, v0
    s_mul_i32 s24, s19, 20480
    s_lshr_b32 s25, s19, 1
    s_lshl_b32 s25, s25, 16
    s_add_u32 s24, s24, s25
    s_and_b32 s25, s19, 1
    s_lshl_b32 s25, s25, 3
    s_add_u32 s24, s24, s25
    v_mul_u32_u24 v20, 1280, v3
    v_lshlrev_b32 v22, 4, v2
    v_add3_u32 v21, v22, v20, s24
    v_lshl_add_u32 v20, v20, 1, v22
    v_add_u32 v22, 5120, v21
    v_add_u32 v23, 10240, v21
    v_add_u32 v24, 15360, v21
    s_mul_i32 s24, s19, 655360
    s_mul_i32 s25, s17, 10240
    s_add_u32 s24, s24, s25
    s_lshl_b32 s25, s47, 8
    s_add_u32 s24, s24, s25
    s_add_u32 s24, s24, 2621440
    s_add_u32 s25, s24, 163840
    s_add_u32 s26, s24, 327680
    s_add_u32 s27, s24, 491520
    s_lshl_b32 s9, s19, 21
    s_lshl_b32 s10, s17, 12
    s_add_u32 s9, s9, s10
    v_and_b32 v11, 7, v0
    v_xor_b32 v10, v3, v11
    v_lshrrev_b32 v11, 3, v0
    v_lshlrev_b32 v11, 17, v11
    v_lshl_add_u32 v10, v10, 4, v11
    v_xor_b32 v11, 64, v10
    v_add_u32 v10, s9, v10
    s_add_u32 s9, s9, 0x100000
    v_add_u32 v11, s9, v11
    s_mul_i32 s8, s19, 5120
    s_add_u32 s8, s8, 53248
    s_mov_b32 s9, 0x10000
    s_mov_b32 s20, s62
    s_mov_b32 s21, s63
    s_mov_b32 s22, 8388608
    s_mov_b32 s23, 0x20000
    s_mov_b32 s28, s64
    s_mov_b32 s29, s65
    s_mov_b32 s30, 8388608
    s_mov_b32 s31, 0x20000
    s_barrier
    ds_read2_b64 v[64:67], v21 offset0:0 offset1:1
    ds_read2_b64 v[68:71], v22 offset0:0 offset1:1
    ds_read2_b64 v[72:75], v23 offset0:0 offset1:1
    ds_read2_b64 v[76:79], v24 offset0:0 offset1:1
    s_waitcnt lgkmcnt(3)
    buffer_store_dwordx4 v[64:67], v20, s[32:35], s24 offen offset:0 sc1
    s_waitcnt lgkmcnt(2)
    buffer_store_dwordx4 v[68:71], v20, s[32:35], s25 offen offset:0 sc1
    s_waitcnt lgkmcnt(1)
    buffer_store_dwordx4 v[72:75], v20, s[32:35], s26 offen offset:0 sc1
    s_waitcnt lgkmcnt(0)
    buffer_store_dwordx4 v[76:79], v20, s[32:35], s27 offen offset:0 sc1
    s_add_u32 m0, s8, 0
    s_nop 0
    buffer_load_dwordx4 v10, s[20:23], 0 offen lds
    s_add_u32 m0, s8, 1024
    s_nop 0
    buffer_load_dwordx4 v11, s[20:23], 0 offen lds
    s_add_u32 m0, s8, 20480
    s_nop 0
    buffer_load_dwordx4 v10, s[28:31], 0 offen lds
    s_add_u32 m0, s8, 21504
    s_nop 0
    buffer_load_dwordx4 v11, s[28:31], 0 offen lds
    s_cmp_lg_u32 s17, 0
    s_cbranch_scc1 A1_NOSEQ
    s_add_u32 m0, s8, 2048
    s_nop 0
    buffer_load_dwordx4 v10, s[20:23], s9 offen lds
    s_add_u32 m0, s8, 3072
    s_nop 0
    buffer_load_dwordx4 v11, s[20:23], s9 offen lds
    s_add_u32 m0, s8, 22528
    s_nop 0
    buffer_load_dwordx4 v10, s[28:31], s9 offen lds
    s_add_u32 m0, s8, 23552
    s_nop 0
    buffer_load_dwordx4 v11, s[28:31], s9 offen lds
A1_NOSEQ:
    s_barrier
    ds_read2_b64 v[64:67], v21 offset0:32 offset1:33
    ds_read2_b64 v[68:71], v22 offset0:32 offset1:33
    ds_read2_b64 v[72:75], v23 offset0:32 offset1:33
    ds_read2_b64 v[76:79], v24 offset0:32 offset1:33
    s_waitcnt lgkmcnt(3)
    buffer_store_dwordx4 v[64:67], v20, s[32:35], s24 offen offset:256 sc1
    s_waitcnt lgkmcnt(2)
    buffer_store_dwordx4 v[68:71], v20, s[32:35], s25 offen offset:256 sc1
    s_waitcnt lgkmcnt(1)
    buffer_store_dwordx4 v[72:75], v20, s[32:35], s26 offen offset:256 sc1
    s_waitcnt lgkmcnt(0)
    buffer_store_dwordx4 v[76:79], v20, s[32:35], s27 offen offset:256 sc1
    s_cbranch_vccz A1_LAST
    s_barrier
    ds_read2_b64 v[64:67], v21 offset0:64 offset1:65
    ds_read2_b64 v[68:71], v22 offset0:64 offset1:65
    ds_read2_b64 v[72:75], v23 offset0:64 offset1:65
    ds_read2_b64 v[76:79], v24 offset0:64 offset1:65
    s_waitcnt lgkmcnt(3)
    buffer_store_dwordx4 v[64:67], v20, s[32:35], s24 offen offset:512 sc1
    s_waitcnt lgkmcnt(2)
    buffer_store_dwordx4 v[68:71], v20, s[32:35], s25 offen offset:512 sc1
    s_waitcnt lgkmcnt(1)
    buffer_store_dwordx4 v[72:75], v20, s[32:35], s26 offen offset:512 sc1
    s_waitcnt lgkmcnt(0)
    buffer_store_dwordx4 v[76:79], v20, s[32:35], s27 offen offset:512 sc1
A1_LAST:
    s_setprio 0
    s_branch A2
A1_PROD:
    v_and_b32 v2, 15, v0
    v_lshlrev_b32 v5, 1, v3
    v_xor_b32 v5, v5, v2
    v_lshlrev_b32 v5, 4, v5
    v_lshl_add_u32 v17, v2, 10, v5
    s_lshl_b32 s24, s19, 8
    v_add_u32 v17, s24, v17
    v_xor_b32 v18, 16, v17
    v_xor_b32 v15, 128, v17
    v_xor_b32 v16, 144, v17
    v_lshrrev_b32 v5, 1, v2
    v_xor_b32 v5, v5, v3
    v_lshlrev_b32 v5, 4, v5
    v_lshl_add_u32 v19, v2, 7, v5
    v_xor_b32 v20, 64, v19
    v_mov_b32 v21, v17
    v_mov_b32 v22, v18
    v_mov_b32 v23, v19
    v_mov_b32 v24, v20
    v_mov_b32 v13, v15
    v_mov_b32 v14, v16
    v_lshlrev_b32 v5, 2, v3
    v_cmp_eq_u32 vcc, 0, v2
    s_mov_b32 s24, 0x3d000000
    v_add_u32 v6, 0, v5
    v_mul_u32_u24 v6, v6, v2
    v_and_b32 v6, 31, v6
    v_cvt_f32_u32 v6, v6
    v_mul_f32 v6, s24, v6
    v_cos_f32 v26, v6
    v_sin_f32 v28, v6
    s_nop 0
    v_cndmask_b32_e64 v28, v28, 1.0, vcc
    v_add_u32 v6, 1, v5
    v_mul_u32_u24 v6, v6, v2
    v_and_b32 v6, 31, v6
    v_cvt_f32_u32 v6, v6
    v_mul_f32 v6, s24, v6
    v_cos_f32 v27, v6
    v_sin_f32 v29, v6
    s_nop 0
    v_cndmask_b32_e64 v29, v29, -1.0, vcc
    v_cvt_pk_bf16_f32 v40, v26, v27
    v_cvt_pk_bf16_f32 v44, v28, v29
    v_add_u32 v6, 2, v5
    v_mul_u32_u24 v6, v6, v2
    v_and_b32 v6, 31, v6
    v_cvt_f32_u32 v6, v6
    v_mul_f32 v6, s24, v6
    v_cos_f32 v26, v6
    v_sin_f32 v28, v6
    s_nop 0
    v_cndmask_b32_e64 v28, v28, 1.0, vcc
    v_add_u32 v6, 3, v5
    v_mul_u32_u24 v6, v6, v2
    v_and_b32 v6, 31, v6
    v_cvt_f32_u32 v6, v6
    v_mul_f32 v6, s24, v6
    v_cos_f32 v27, v6
    v_sin_f32 v29, v6
    s_nop 0
    v_cndmask_b32_e64 v29, v29, -1.0, vcc
    v_cvt_pk_bf16_f32 v41, v26, v27
    v_cvt_pk_bf16_f32 v45, v28, v29
    v_add_u32 v6, 16, v5
    v_mul_u32_u24 v6, v6, v2
    v_and_b32 v6, 31, v6
    v_cvt_f32_u32 v6, v6
    v_mul_f32 v6, s24, v6
    v_cos_f32 v26, v6
    v_sin_f32 v28, v6
    s_nop 0
    v_cndmask_b32_e64 v28, v28, 1.0, vcc
    v_add_u32 v6, 17, v5
    v_mul_u32_u24 v6, v6, v2
    v_and_b32 v6, 31, v6
    v_cvt_f32_u32 v6, v6
    v_mul_f32 v6, s24, v6
    v_cos_f32 v27, v6
    v_sin_f32 v29, v6
    s_nop 0
    v_cndmask_b32_e64 v29, v29, -1.0, vcc
    v_cvt_pk_bf16_f32 v42, v26, v27
    v_cvt_pk_bf16_f32 v46, v28, v29
    v_add_u32 v6, 18, v5
    v_mul_u32_u24 v6, v6, v2
    v_and_b32 v6, 31, v6
    v_cvt_f32_u32 v6, v6
    v_mul_f32 v6, s24, v6
    v_cos_f32 v26, v6
    v_sin_f32 v28, v6
    s_nop 0
    v_cndmask_b32_e64 v28, v28, 1.0, vcc
    v_add_u32 v6, 19, v5
    v_mul_u32_u24 v6, v6, v2
    v_and_b32 v6, 31, v6
    v_cvt_f32_u32 v6, v6
    v_mul_f32 v6, s24, v6
    v_cos_f32 v27, v6
    v_sin_f32 v29, v6
    s_nop 0
    v_cndmask_b32_e64 v29, v29, -1.0, vcc
    v_cvt_pk_bf16_f32 v43, v26, v27
    v_cvt_pk_bf16_f32 v47, v28, v29
    s_cmp_eq_u32 s18, 0
    s_cselect_b64 s[44:45], vcc, 0
    v_mul_u32_u24 v5, 20480, v3
    v_and_b32 v6, 1, v3
    v_lshl_add_u32 v5, v6, 3, v5
    v_lshrrev_b32 v6, 1, v3
    v_lshl_add_u32 v5, v6, 16, v5
    v_lshl_add_u32 v5, v2, 4, v5
    s_lshl_b32 s24, s19, 2
    v_add_u32 v5, s24, v5
    s_lshl_b32 s24, s47, 4
    s_mov_b32 s25, 0x3acccccd
    v_add_u32 v6, s24, v2
    v_cvt_f32_u32 v6, v6
    v_mul_f32 v6, s25, v6
    v_cos_f32 v48, v6
    v_sin_f32 v49, v6
    s_add_u32 s24, s24, 16
    v_add_u32 v6, s24, v2
    v_cvt_f32_u32 v6, v6
    v_mul_f32 v6, s25, v6
    v_cos_f32 v50, v6
    v_sin_f32 v51, v6
    s_add_u32 s24, s24, 16
    v_add_u32 v6, s24, v2
    v_cvt_f32_u32 v6, v6
    v_mul_f32 v6, s25, v6
    v_cos_f32 v52, v6
    v_sin_f32 v53, v6
    s_add_u32 s24, s24, 16
    v_mov_b32 v56, 0
    v_mov_b32 v57, 0
    v_mov_b32 v58, 0
    v_mov_b32 v59, 0
    v_mov_b32 v60, 0
    v_mov_b32 v61, 0
    v_mov_b32 v62, 0
    v_mov_b32 v63, 0
    v_mov_b32 v64, 0
    v_mov_b32 v65, 0
    v_mov_b32 v66, 0
    v_mov_b32 v67, 0
    v_mov_b32 v68, 0
    v_mov_b32 v69, 0
    v_mov_b32 v70, 0
    v_mov_b32 v71, 0
    v_mov_b32 v72, 0
    v_mov_b32 v73, 0
    v_mov_b32 v74, 0
    v_mov_b32 v75, 0
    v_mov_b32 v76, 0
    v_mov_b32 v77, 0
    v_mov_b32 v78, 0
    v_mov_b32 v79, 0
    v_mov_b32 v80, 0
    v_mov_b32 v81, 0
    v_mov_b32 v82, 0
    v_mov_b32 v83, 0
    v_mov_b32 v84, 0
    v_mov_b32 v85, 0
    v_mov_b32 v86, 0
    v_mov_b32 v87, 0
    v_mov_b32 v88, 0
    v_mov_b32 v89, 0
    v_mov_b32 v90, 0
    v_mov_b32 v91, 0
    v_mov_b32 v92, 0
    v_mov_b32 v93, 0
    v_mov_b32 v94, 0
    v_mov_b32 v95, 0
    v_mov_b32 v96, 0
    v_mov_b32 v97, 0
    v_mov_b32 v98, 0
    v_mov_b32 v99, 0
    v_mov_b32 v100, 0
    v_mov_b32 v101, 0
    v_mov_b32 v102, 0
    v_mov_b32 v103, 0
    v_mov_b32 v104, 0
    v_mov_b32 v105, 0
    v_mov_b32 v106, 0
    v_mov_b32 v107, 0
    v_mov_b32 v108, 0
    v_mov_b32 v109, 0
    v_mov_b32 v110, 0
    v_mov_b32 v111, 0
    v_mov_b32 v112, 0
    v_mov_b32 v113, 0
    v_mov_b32 v114, 0
    v_mov_b32 v115, 0
    v_mov_b32 v116, 0
    v_mov_b32 v117, 0
    v_mov_b32 v118, 0
    v_mov_b32 v119, 0
    v_mov_b32 v120, 0
    v_mov_b32 v121, 0
    v_mov_b32 v122, 0
    v_mov_b32 v123, 0
    v_mov_b32 v124, 0
    v_mov_b32 v125, 0
    v_mov_b32 v126, 0
    v_mov_b32 v127, 0
    v_mov_b32 v128, 0
    v_mov_b32 v129, 0
    v_mov_b32 v130, 0
    v_mov_b32 v131, 0
    v_mov_b32 v132, 0
    v_mov_b32 v133, 0
    v_mov_b32 v134, 0
    v_mov_b32 v135, 0
    v_mov_b32 v136, 0
    v_mov_b32 v137, 0
    v_mov_b32 v138, 0
    v_mov_b32 v139, 0
    v_mov_b32 v140, 0
    v_mov_b32 v141, 0
    v_mov_b32 v142, 0
    v_mov_b32 v143, 0
    v_mov_b32 v144, 0
    v_mov_b32 v145, 0
    v_mov_b32 v146, 0
    v_mov_b32 v147, 0
    v_mov_b32 v148, 0
    v_mov_b32 v149, 0
    v_mov_b32 v150, 0
    v_mov_b32 v151, 0
    s_mov_b32 s42, 0
    s_mov_b32 s43, 53248
    s_waitcnt lgkmcnt(0)
    s_mov_b32 s32, s80
    s_mov_b32 s33, s81
    s_mov_b32 s34, 5312512
    s_mov_b32 s35, 0x20000
    s_cmp_ge_u32 s18, 2
    s_cbranch_scc1 A1_U2
    s_barrier
    ds_read_b128 v[152:155], v21 offset:0
    ds_read_b128 v[156:159], v22 offset:0
    ds_read_b128 v[160:163], v21 offset:16384
    ds_read_b128 v[164:167], v22 offset:16384
    ds_read_b128 v[200:203], v23 offset:32768
    ds_read_b128 v[204:207], v23 offset:34816
    ds_read_b128 v[208:211], v23 offset:36864
    ds_read_b128 v[212:215], v23 offset:38912
    ds_read_b128 v[216:219], v23 offset:40960
    ds_read_b128 v[220:223], v23 offset:43008
    s_waitcnt lgkmcnt(6)
    v_perm_b32 v168, v153, v152, s48
    v_perm_b32 v172, v153, v152, s49
    v_perm_b32 v169, v155, v154, s48
    v_perm_b32 v173, v155, v154, s49
    v_perm_b32 v170, v157, v156, s48
    v_perm_b32 v174, v157, v156, s49
    v_perm_b32 v171, v159, v158, s48
    v_perm_b32 v175, v159, v158, s49
    v_perm_b32 v176, v161, v160, s48
    v_perm_b32 v180, v161, v160, s49
    v_perm_b32 v177, v163, v162, s48
    v_perm_b32 v181, v163, v162, s49
    v_perm_b32 v178, v165, v164, s48
    v_perm_b32 v182, v165, v164, s49
    v_perm_b32 v179, v167, v166, s48
    v_perm_b32 v183, v167, v166, s49
    s_branch A1U3_MID
A1U3_LOOP:
    s_barrier
    v_mfma_f32_16x16x32_bf16 v[56:59], v[184:187], v[224:227], v[56:59]
    ds_read_b128 v[152:155], v21 offset:0
    v_mfma_f32_16x16x32_bf16 v[60:63], v[192:195], v[224:227], v[60:63]
    ds_read_b128 v[156:159], v22 offset:0
    v_mfma_f32_16x16x32_bf16 v[64:67], v[188:191], v[224:227], v[64:67]
    ds_read_b128 v[160:163], v21 offset:16384
    v_mfma_f32_16x16x32_bf16 v[68:71], v[196:199], v[224:227], v[68:71]
    ds_read_b128 v[164:167], v22 offset:16384
    v_mfma_f32_16x16x32_bf16 v[72:75], v[184:187], v[228:231], v[72:75]
    ds_read_b128 v[200:203], v23 offset:32768
    v_mfma_f32_16x16x32_bf16 v[76:79], v[192:195], v[228:231], v[76:79]
    ds_read_b128 v[204:207], v23 offset:34816
    v_mfma_f32_16x16x32_bf16 v[80:83], v[188:191], v[228:231], v[80:83]
    ds_read_b128 v[208:211], v23 offset:36864
    v_mfma_f32_16x16x32_bf16 v[84:87], v[196:199], v[228:231], v[84:87]
    ds_read_b128 v[212:215], v23 offset:38912
    v_mfma_f32_16x16x32_bf16 v[88:91], v[184:187], v[232:235], v[88:91]
    ds_read_b128 v[216:219], v23 offset:40960
    s_waitcnt lgkmcnt(5)
    v_perm_b32 v168, v153, v152, s48
    v_mfma_f32_16x16x32_bf16 v[92:95], v[192:195], v[232:235], v[92:95]
    ds_read_b128 v[220:223], v23 offset:43008
    v_perm_b32 v172, v153, v152, s49
    v_mfma_f32_16x16x32_bf16 v[96:99], v[188:191], v[232:235], v[96:99]
    v_perm_b32 v169, v155, v154, s48
    v_mfma_f32_16x16x32_bf16 v[100:103], v[196:199], v[232:235], v[100:103]
    v_perm_b32 v173, v155, v154, s49
    v_mfma_f32_16x16x32_bf16 v[104:107], v[184:187], v[236:239], v[104:107]
    v_perm_b32 v170, v157, v156, s48
    v_mfma_f32_16x16x32_bf16 v[108:111], v[192:195], v[236:239], v[108:111]
    v_perm_b32 v174, v157, v156, s49
    v_mfma_f32_16x16x32_bf16 v[112:115], v[188:191], v[236:239], v[112:115]
    v_perm_b32 v171, v159, v158, s48
    v_mfma_f32_16x16x32_bf16 v[116:119], v[196:199], v[236:239], v[116:119]
    v_perm_b32 v175, v159, v158, s49
    v_mfma_f32_16x16x32_bf16 v[120:123], v[184:187], v[240:243], v[120:123]
    v_perm_b32 v176, v161, v160, s48
    v_mfma_f32_16x16x32_bf16 v[124:127], v[192:195], v[240:243], v[124:127]
    v_perm_b32 v180, v161, v160, s49
    v_mfma_f32_16x16x32_bf16 v[128:131], v[188:191], v[240:243], v[128:131]
    v_perm_b32 v177, v163, v162, s48
    v_mfma_f32_16x16x32_bf16 v[132:135], v[196:199], v[240:243], v[132:135]
    v_perm_b32 v181, v163, v162, s49
    v_mfma_f32_16x16x32_bf16 v[136:139], v[184:187], v[244:247], v[136:139]
    v_perm_b32 v178, v165, v164, s48
    v_mfma_f32_16x16x32_bf16 v[140:143], v[192:195], v[244:247], v[140:143]
    v_perm_b32 v182, v165, v164, s49
    v_mfma_f32_16x16x32_bf16 v[144:147], v[188:191], v[244:247], v[144:147]
    v_perm_b32 v179, v167, v166, s48
    v_mfma_f32_16x16x32_bf16 v[148:151], v[196:199], v[244:247], v[148:151]
    v_perm_b32 v183, v167, v166, s49
A1U3_MID:
    s_waitcnt lgkmcnt(0)
    v_mfma_f32_16x16x32_bf16 v[56:59], v[168:171], v[200:203], v[56:59]
    ds_read_b128 v[152:155], v13 offset:0
    v_mfma_f32_16x16x32_bf16 v[60:63], v[176:179], v[200:203], v[60:63]
    ds_read_b128 v[156:159], v14 offset:0
    v_mfma_f32_16x16x32_bf16 v[64:67], v[172:175], v[200:203], v[64:67]
    ds_read_b128 v[160:163], v13 offset:16384
    v_mfma_f32_16x16x32_bf16 v[68:71], v[180:183], v[200:203], v[68:71]
    ds_read_b128 v[164:167], v14 offset:16384
    v_mfma_f32_16x16x32_bf16 v[72:75], v[168:171], v[204:207], v[72:75]
    ds_read_b128 v[224:227], v24 offset:32768
    v_mfma_f32_16x16x32_bf16 v[76:79], v[176:179], v[204:207], v[76:79]
    ds_read_b128 v[228:231], v24 offset:34816
    v_mfma_f32_16x16x32_bf16 v[80:83], v[172:175], v[204:207], v[80:83]
    ds_read_b128 v[232:235], v24 offset:36864
    v_mfma_f32_16x16x32_bf16 v[84:87], v[180:183], v[204:207], v[84:87]
    ds_read_b128 v[236:239], v24 offset:38912
    v_mfma_f32_16x16x32_bf16 v[88:91], v[168:171], v[208:211], v[88:91]
    ds_read_b128 v[240:243], v24 offset:40960
    s_waitcnt lgkmcnt(5)
    v_perm_b32 v184, v153, v152, s48
    v_mfma_f32_16x16x32_bf16 v[92:95], v[176:179], v[208:211], v[92:95]
    ds_read_b128 v[244:247], v24 offset:43008
    v_perm_b32 v188, v153, v152, s49
    v_mfma_f32_16x16x32_bf16 v[96:99], v[172:175], v[208:211], v[96:99]
    v_add_u32 v21, s43, v17
    v_add_u32 v22, s43, v18
    v_perm_b32 v185, v155, v154, s48
    v_mfma_f32_16x16x32_bf16 v[100:103], v[180:183], v[208:211], v[100:103]
    v_add_u32 v23, s43, v19
    v_add_u32 v24, s43, v20
    v_add_u32 v13, s43, v15
    v_add_u32 v14, s43, v16
    v_perm_b32 v189, v155, v154, s49
    v_mfma_f32_16x16x32_bf16 v[104:107], v[168:171], v[212:215], v[104:107]
    s_add_u32 s43, s43, 53248
    s_cmp_eq_u32 s43, 159744
    v_perm_b32 v186, v157, v156, s48
    v_mfma_f32_16x16x32_bf16 v[108:111], v[176:179], v[212:215], v[108:111]
    s_cselect_b32 s43, 0, s43
    s_add_u32 s42, s42, 1
    v_perm_b32 v190, v157, v156, s49
    v_mfma_f32_16x16x32_bf16 v[112:115], v[172:175], v[212:215], v[112:115]
    s_cmp_lt_u32 s42, 5
    v_perm_b32 v187, v159, v158, s48
    v_mfma_f32_16x16x32_bf16 v[116:119], v[180:183], v[212:215], v[116:119]
    v_perm_b32 v191, v159, v158, s49
    v_mfma_f32_16x16x32_bf16 v[120:123], v[168:171], v[216:219], v[120:123]
    v_perm_b32 v192, v161, v160, s48
    v_mfma_f32_16x16x32_bf16 v[124:127], v[176:179], v[216:219], v[124:127]
    v_perm_b32 v196, v161, v160, s49
    v_mfma_f32_16x16x32_bf16 v[128:131], v[172:175], v[216:219], v[128:131]
    v_perm_b32 v193, v163, v162, s48
    v_mfma_f32_16x16x32_bf16 v[132:135], v[180:183], v[216:219], v[132:135]
    v_perm_b32 v197, v163, v162, s49
    v_mfma_f32_16x16x32_bf16 v[136:139], v[168:171], v[220:223], v[136:139]
    v_perm_b32 v194, v165, v164, s48
    v_mfma_f32_16x16x32_bf16 v[140:143], v[176:179], v[220:223], v[140:143]
    v_perm_b32 v198, v165, v164, s49
    v_mfma_f32_16x16x32_bf16 v[144:147], v[172:175], v[220:223], v[144:147]
    v_perm_b32 v195, v167, v166, s48
    v_mfma_f32_16x16x32_bf16 v[148:151], v[180:183], v[220:223], v[148:151]
    v_perm_b32 v199, v167, v166, s49
    s_waitcnt lgkmcnt(0)
    s_cbranch_scc1 A1U3_LOOP
    v_mfma_f32_16x16x32_bf16 v[56:59], v[184:187], v[224:227], v[56:59]
    v_mfma_f32_16x16x32_bf16 v[60:63], v[192:195], v[224:227], v[60:63]
    v_mfma_f32_16x16x32_bf16 v[64:67], v[188:191], v[224:227], v[64:67]
    v_mfma_f32_16x16x32_bf16 v[68:71], v[196:199], v[224:227], v[68:71]
    v_mfma_f32_16x16x32_bf16 v[72:75], v[184:187], v[228:231], v[72:75]
    v_mfma_f32_16x16x32_bf16 v[76:79], v[192:195], v[228:231], v[76:79]
    v_mfma_f32_16x16x32_bf16 v[80:83], v[188:191], v[228:231], v[80:83]
    v_mfma_f32_16x16x32_bf16 v[84:87], v[196:199], v[228:231], v[84:87]
    v_mfma_f32_16x16x32_bf16 v[88:91], v[184:187], v[232:235], v[88:91]
    v_mfma_f32_16x16x32_bf16 v[92:95], v[192:195], v[232:235], v[92:95]
    v_mfma_f32_16x16x32_bf16 v[96:99], v[188:191], v[232:235], v[96:99]
    v_mfma_f32_16x16x32_bf16 v[100:103], v[196:199], v[232:235], v[100:103]
    v_mfma_f32_16x16x32_bf16 v[104:107], v[184:187], v[236:239], v[104:107]
    v_mfma_f32_16x16x32_bf16 v[108:111], v[192:195], v[236:239], v[108:111]
    v_mfma_f32_16x16x32_bf16 v[112:115], v[188:191], v[236:239], v[112:115]
    v_mfma_f32_16x16x32_bf16 v[116:119], v[196:199], v[236:239], v[116:119]
    v_mfma_f32_16x16x32_bf16 v[120:123], v[184:187], v[240:243], v[120:123]
    v_mfma_f32_16x16x32_bf16 v[124:127], v[192:195], v[240:243], v[124:127]
    v_mfma_f32_16x16x32_bf16 v[128:131], v[188:191], v[240:243], v[128:131]
    v_mfma_f32_16x16x32_bf16 v[132:135], v[196:199], v[240:243], v[132:135]
    v_mfma_f32_16x16x32_bf16 v[136:139], v[184:187], v[244:247], v[136:139]
    v_mfma_f32_16x16x32_bf16 v[140:143], v[192:195], v[244:247], v[140:143]
    v_mfma_f32_16x16x32_bf16 v[144:147], v[188:191], v[244:247], v[144:147]
    v_mfma_f32_16x16x32_bf16 v[148:151], v[196:199], v[244:247], v[148:151]
    v_pk_mul_f32 v[26:27], v[48:49], v[64:65] op_sel_hi:[0,1]
    v_pk_mul_f32 v[28:29], v[48:49], v[64:65] op_sel:[1,0] op_sel_hi:[1,1]
    v_pk_fma_f32 v[26:27], v[48:49], v[80:81], v[26:27] op_sel:[1,0,0] op_sel_hi:[1,1,1]
    v_pk_fma_f32 v[28:29], v[48:49], v[80:81], v[28:29] op_sel_hi:[0,1,1] neg_lo:[1,0,0] neg_hi:[1,0,0]
    v_pk_add_f32 v[64:65], v[56:57], v[26:27] neg_lo:[0,1] neg_hi:[0,1]
    v_pk_add_f32 v[56:57], v[56:57], v[26:27]
    v_pk_add_f32 v[26:27], v[28:29], v[72:73] neg_lo:[0,1] neg_hi:[0,1]
    v_pk_add_f32 v[28:29], v[28:29], v[72:73]
    v_cndmask_b32_e64 v72, v26, v72, s[44:45]
    v_cndmask_b32_e64 v80, v28, v80, s[44:45]
    v_cndmask_b32_e64 v73, v27, v73, s[44:45]
    v_cndmask_b32_e64 v81, v29, v81, s[44:45]
    v_pk_mul_f32 v[30:31], v[48:49], v[66:67] op_sel_hi:[0,1]
    v_pk_mul_f32 v[32:33], v[48:49], v[66:67] op_sel:[1,0] op_sel_hi:[1,1]
    v_pk_fma_f32 v[30:31], v[48:49], v[82:83], v[30:31] op_sel:[1,0,0] op_sel_hi:[1,1,1]
    v_pk_fma_f32 v[32:33], v[48:49], v[82:83], v[32:33] op_sel_hi:[0,1,1] neg_lo:[1,0,0] neg_hi:[1,0,0]
    v_pk_add_f32 v[66:67], v[58:59], v[30:31] neg_lo:[0,1] neg_hi:[0,1]
    v_pk_add_f32 v[58:59], v[58:59], v[30:31]
    v_pk_add_f32 v[30:31], v[32:33], v[74:75] neg_lo:[0,1] neg_hi:[0,1]
    v_pk_add_f32 v[32:33], v[32:33], v[74:75]
    v_cndmask_b32_e64 v74, v30, v74, s[44:45]
    v_cndmask_b32_e64 v82, v32, v82, s[44:45]
    v_cndmask_b32_e64 v75, v31, v75, s[44:45]
    v_cndmask_b32_e64 v83, v33, v83, s[44:45]
    v_pk_mul_f32 v[26:27], v[48:49], v[68:69] op_sel_hi:[0,1]
    v_pk_mul_f32 v[28:29], v[48:49], v[68:69] op_sel:[1,0] op_sel_hi:[1,1]
    v_pk_fma_f32 v[26:27], v[48:49], v[84:85], v[26:27] op_sel:[1,0,0] op_sel_hi:[1,1,1]
    v_pk_fma_f32 v[28:29], v[48:49], v[84:85], v[28:29] op_sel_hi:[0,1,1] neg_lo:[1,0,0] neg_hi:[1,0,0]
    v_pk_add_f32 v[68:69], v[60:61], v[26:27] neg_lo:[0,1] neg_hi:[0,1]
    v_pk_add_f32 v[60:61], v[60:61], v[26:27]
    v_pk_add_f32 v[26:27], v[28:29], v[76:77] neg_lo:[0,1] neg_hi:[0,1]
    v_pk_add_f32 v[28:29], v[28:29], v[76:77]
    v_cndmask_b32_e64 v76, v26, v76, s[44:45]
    v_cndmask_b32_e64 v84, v28, v84, s[44:45]
    v_cndmask_b32_e64 v77, v27, v77, s[44:45]
    v_cndmask_b32_e64 v85, v29, v85, s[44:45]
    v_pk_mul_f32 v[30:31], v[48:49], v[70:71] op_sel_hi:[0,1]
    v_pk_mul_f32 v[32:33], v[48:49], v[70:71] op_sel:[1,0] op_sel_hi:[1,1]
    v_pk_fma_f32 v[30:31], v[48:49], v[86:87], v[30:31] op_sel:[1,0,0] op_sel_hi:[1,1,1]
    v_pk_fma_f32 v[32:33], v[48:49], v[86:87], v[32:33] op_sel_hi:[0,1,1] neg_lo:[1,0,0] neg_hi:[1,0,0]
    v_pk_add_f32 v[70:71], v[62:63], v[30:31] neg_lo:[0,1] neg_hi:[0,1]
    v_pk_add_f32 v[62:63], v[62:63], v[30:31]
    v_pk_add_f32 v[30:31], v[32:33], v[78:79] neg_lo:[0,1] neg_hi:[0,1]
    v_pk_add_f32 v[32:33], v[32:33], v[78:79]
    v_cndmask_b32_e64 v78, v30, v78, s[44:45]
    v_cndmask_b32_e64 v86, v32, v86, s[44:45]
    v_cndmask_b32_e64 v79, v31, v79, s[44:45]
    v_cndmask_b32_e64 v87, v33, v87, s[44:45]
    v_cvt_pk_bf16_f32 v152, v56, v57
    v_cvt_pk_bf16_f32 v153, v58, v59
    v_cvt_pk_bf16_f32 v154, v60, v61
    v_cvt_pk_bf16_f32 v155, v62, v63
    v_cvt_pk_bf16_f32 v156, v64, v65
    v_cvt_pk_bf16_f32 v157, v66, v67
    v_cvt_pk_bf16_f32 v158, v68, v69
    v_cvt_pk_bf16_f32 v159, v70, v71
    v_mfma_f32_16x16x32_bf16 v[200:203], v[40:43], v[152:155], 0
    v_mfma_f32_16x16x32_bf16 v[204:207], v[44:47], v[152:155], 0
    v_cvt_pk_bf16_f32 v160, v72, v73
    v_cvt_pk_bf16_f32 v161, v74, v75
    v_cvt_pk_bf16_f32 v162, v76, v77
    v_cvt_pk_bf16_f32 v163, v78, v79
    v_mfma_f32_16x16x32_bf16 v[208:211], v[40:43], v[156:159], 0
    v_mfma_f32_16x16x32_bf16 v[212:215], v[44:47], v[156:159], 0
    v_cvt_pk_bf16_f32 v164, v80, v81
    v_cvt_pk_bf16_f32 v165, v82, v83
    v_cvt_pk_bf16_f32 v166, v84, v85
    v_cvt_pk_bf16_f32 v167, v86, v87
    v_mfma_f32_16x16x32_bf16 v[216:219], v[40:43], v[160:163], 0
    v_mfma_f32_16x16x32_bf16 v[220:223], v[44:47], v[160:163], 0
    v_mfma_f32_16x16x32_bf16 v[224:227], v[40:43], v[164:167], 0
    v_mfma_f32_16x16x32_bf16 v[228:231], v[44:47], v[164:167], 0
    v_cvt_pk_bf16_f32 v168, v200, v204
    ds_write_b32 v5, v168 offset:0
    v_cvt_pk_bf16_f32 v169, v201, v205
    ds_write_b32 v5, v169 offset:5120
    v_cvt_pk_bf16_f32 v170, v202, v206
    ds_write_b32 v5, v170 offset:10240
    v_cvt_pk_bf16_f32 v171, v203, v207
    ds_write_b32 v5, v171 offset:15360
    v_cvt_pk_bf16_f32 v172, v208, v212
    ds_write_b32 v5, v172 offset:1280
    v_cvt_pk_bf16_f32 v173, v209, v213
    ds_write_b32 v5, v173 offset:6400
    v_cvt_pk_bf16_f32 v174, v210, v214
    ds_write_b32 v5, v174 offset:11520
    v_cvt_pk_bf16_f32 v175, v211, v215
    ds_write_b32 v5, v175 offset:16640
    v_cvt_pk_bf16_f32 v176, v216, v220
    ds_write_b32 v5, v176 offset:2560
    v_cvt_pk_bf16_f32 v177, v217, v221
    ds_write_b32 v5, v177 offset:7680
    v_cvt_pk_bf16_f32 v178, v218, v222
    ds_write_b32 v5, v178 offset:12800
    v_cvt_pk_bf16_f32 v179, v219, v223
    ds_write_b32 v5, v179 offset:17920
    v_cvt_pk_bf16_f32 v180, v224, v228
    ds_write_b32 v5, v180 offset:3840
    v_cvt_pk_bf16_f32 v181, v225, v229
    ds_write_b32 v5, v181 offset:8960
    v_cvt_pk_bf16_f32 v182, v226, v230
    ds_write_b32 v5, v182 offset:14080
    v_cvt_pk_bf16_f32 v183, v227, v231
    ds_write_b32 v5, v183 offset:19200
    s_waitcnt lgkmcnt(0)
    s_barrier
    v_pk_mul_f32 v[26:27], v[50:51], v[96:97] op_sel_hi:[0,1]
    v_pk_mul_f32 v[28:29], v[50:51], v[96:97] op_sel:[1,0] op_sel_hi:[1,1]
    v_pk_fma_f32 v[26:27], v[50:51], v[112:113], v[26:27] op_sel:[1,0,0] op_sel_hi:[1,1,1]
    v_pk_fma_f32 v[28:29], v[50:51], v[112:113], v[28:29] op_sel_hi:[0,1,1] neg_lo:[1,0,0] neg_hi:[1,0,0]
    v_pk_add_f32 v[96:97], v[88:89], v[26:27] neg_lo:[0,1] neg_hi:[0,1]
    v_pk_add_f32 v[88:89], v[88:89], v[26:27]
    v_pk_add_f32 v[112:113], v[28:29], v[104:105]
    v_pk_add_f32 v[104:105], v[28:29], v[104:105] neg_lo:[0,1] neg_hi:[0,1]
    v_pk_mul_f32 v[30:31], v[50:51], v[98:99] op_sel_hi:[0,1]
    v_pk_mul_f32 v[32:33], v[50:51], v[98:99] op_sel:[1,0] op_sel_hi:[1,1]
    v_pk_fma_f32 v[30:31], v[50:51], v[114:115], v[30:31] op_sel:[1,0,0] op_sel_hi:[1,1,1]
    v_pk_fma_f32 v[32:33], v[50:51], v[114:115], v[32:33] op_sel_hi:[0,1,1] neg_lo:[1,0,0] neg_hi:[1,0,0]
    v_pk_add_f32 v[98:99], v[90:91], v[30:31] neg_lo:[0,1] neg_hi:[0,1]
    v_pk_add_f32 v[90:91], v[90:91], v[30:31]
    v_pk_add_f32 v[114:115], v[32:33], v[106:107]
    v_pk_add_f32 v[106:107], v[32:33], v[106:107] neg_lo:[0,1] neg_hi:[0,1]
    v_pk_mul_f32 v[26:27], v[50:51], v[100:101] op_sel_hi:[0,1]
    v_pk_mul_f32 v[28:29], v[50:51], v[100:101] op_sel:[1,0] op_sel_hi:[1,1]
    v_pk_fma_f32 v[26:27], v[50:51], v[116:117], v[26:27] op_sel:[1,0,0] op_sel_hi:[1,1,1]
    v_pk_fma_f32 v[28:29], v[50:51], v[116:117], v[28:29] op_sel_hi:[0,1,1] neg_lo:[1,0,0] neg_hi:[1,0,0]
    v_pk_add_f32 v[100:101], v[92:93], v[26:27] neg_lo:[0,1] neg_hi:[0,1]
    v_pk_add_f32 v[92:93], v[92:93], v[26:27]
    v_pk_add_f32 v[116:117], v[28:29], v[108:109]
    v_pk_add_f32 v[108:109], v[28:29], v[108:109] neg_lo:[0,1] neg_hi:[0,1]
    v_pk_mul_f32 v[30:31], v[50:51], v[102:103] op_sel_hi:[0,1]
    v_pk_mul_f32 v[32:33], v[50:51], v[102:103] op_sel:[1,0] op_sel_hi:[1,1]
    v_pk_fma_f32 v[30:31], v[50:51], v[118:119], v[30:31] op_sel:[1,0,0] op_sel_hi:[1,1,1]
    v_pk_fma_f32 v[32:33], v[50:51], v[118:119], v[32:33] op_sel_hi:[0,1,1] neg_lo:[1,0,0] neg_hi:[1,0,0]
    v_pk_add_f32 v[102:103], v[94:95], v[30:31] neg_lo:[0,1] neg_hi:[0,1]
    v_pk_add_f32 v[94:95], v[94:95], v[30:31]
    v_pk_add_f32 v[118:119], v[32:33], v[110:111]
    v_pk_add_f32 v[110:111], v[32:33], v[110:111] neg_lo:[0,1] neg_hi:[0,1]
    v_cvt_pk_bf16_f32 v152, v88, v89
    v_cvt_pk_bf16_f32 v153, v90, v91
    v_cvt_pk_bf16_f32 v154, v92, v93
    v_cvt_pk_bf16_f32 v155, v94, v95
    v_cvt_pk_bf16_f32 v156, v96, v97
    v_cvt_pk_bf16_f32 v157, v98, v99
    v_cvt_pk_bf16_f32 v158, v100, v101
    v_cvt_pk_bf16_f32 v159, v102, v103
    v_mfma_f32_16x16x32_bf16 v[200:203], v[40:43], v[152:155], 0
    v_mfma_f32_16x16x32_bf16 v[204:207], v[44:47], v[152:155], 0
    v_cvt_pk_bf16_f32 v160, v104, v105
    v_cvt_pk_bf16_f32 v161, v106, v107
    v_cvt_pk_bf16_f32 v162, v108, v109
    v_cvt_pk_bf16_f32 v163, v110, v111
    v_mfma_f32_16x16x32_bf16 v[208:211], v[40:43], v[156:159], 0
    v_mfma_f32_16x16x32_bf16 v[212:215], v[44:47], v[156:159], 0
    v_cvt_pk_bf16_f32 v164, v112, v113
    v_cvt_pk_bf16_f32 v165, v114, v115
    v_cvt_pk_bf16_f32 v166, v116, v117
    v_cvt_pk_bf16_f32 v167, v118, v119
    v_mfma_f32_16x16x32_bf16 v[216:219], v[40:43], v[160:163], 0
    v_mfma_f32_16x16x32_bf16 v[220:223], v[44:47], v[160:163], 0
    v_mfma_f32_16x16x32_bf16 v[224:227], v[40:43], v[164:167], 0
    v_mfma_f32_16x16x32_bf16 v[228:231], v[44:47], v[164:167], 0
    v_cvt_pk_bf16_f32 v168, v200, v204
    ds_write_b32 v5, v168 offset:256
    v_cvt_pk_bf16_f32 v169, v201, v205
    ds_write_b32 v5, v169 offset:5376
    v_cvt_pk_bf16_f32 v170, v202, v206
    ds_write_b32 v5, v170 offset:10496
    v_cvt_pk_bf16_f32 v171, v203, v207
    ds_write_b32 v5, v171 offset:15616
    v_cvt_pk_bf16_f32 v172, v208, v212
    ds_write_b32 v5, v172 offset:1536
    v_cvt_pk_bf16_f32 v173, v209, v213
    ds_write_b32 v5, v173 offset:6656
    v_cvt_pk_bf16_f32 v174, v210, v214
    ds_write_b32 v5, v174 offset:11776
    v_cvt_pk_bf16_f32 v175, v211, v215
    ds_write_b32 v5, v175 offset:16896
    v_cvt_pk_bf16_f32 v176, v216, v220
    ds_write_b32 v5, v176 offset:2816
    v_cvt_pk_bf16_f32 v177, v217, v221
    ds_write_b32 v5, v177 offset:7936
    v_cvt_pk_bf16_f32 v178, v218, v222
    ds_write_b32 v5, v178 offset:13056
    v_cvt_pk_bf16_f32 v179, v219, v223
    ds_write_b32 v5, v179 offset:18176
    v_cvt_pk_bf16_f32 v180, v224, v228
    ds_write_b32 v5, v180 offset:4096
    v_cvt_pk_bf16_f32 v181, v225, v229
    ds_write_b32 v5, v181 offset:9216
    v_cvt_pk_bf16_f32 v182, v226, v230
    ds_write_b32 v5, v182 offset:14336
    v_cvt_pk_bf16_f32 v183, v227, v231
    ds_write_b32 v5, v183 offset:19456
    s_waitcnt lgkmcnt(0)
    s_barrier
    v_pk_mul_f32 v[26:27], v[52:53], v[128:129] op_sel_hi:[0,1]
    v_pk_mul_f32 v[28:29], v[52:53], v[128:129] op_sel:[1,0] op_sel_hi:[1,1]
    v_pk_fma_f32 v[26:27], v[52:53], v[144:145], v[26:27] op_sel:[1,0,0] op_sel_hi:[1,1,1]
    v_pk_fma_f32 v[28:29], v[52:53], v[144:145], v[28:29] op_sel_hi:[0,1,1] neg_lo:[1,0,0] neg_hi:[1,0,0]
    v_pk_add_f32 v[128:129], v[120:121], v[26:27] neg_lo:[0,1] neg_hi:[0,1]
    v_pk_add_f32 v[120:121], v[120:121], v[26:27]
    v_pk_add_f32 v[144:145], v[28:29], v[136:137]
    v_pk_add_f32 v[136:137], v[28:29], v[136:137] neg_lo:[0,1] neg_hi:[0,1]
    v_pk_mul_f32 v[30:31], v[52:53], v[130:131] op_sel_hi:[0,1]
    v_pk_mul_f32 v[32:33], v[52:53], v[130:131] op_sel:[1,0] op_sel_hi:[1,1]
    v_pk_fma_f32 v[30:31], v[52:53], v[146:147], v[30:31] op_sel:[1,0,0] op_sel_hi:[1,1,1]
    v_pk_fma_f32 v[32:33], v[52:53], v[146:147], v[32:33] op_sel_hi:[0,1,1] neg_lo:[1,0,0] neg_hi:[1,0,0]
    v_pk_add_f32 v[130:131], v[122:123], v[30:31] neg_lo:[0,1] neg_hi:[0,1]
    v_pk_add_f32 v[122:123], v[122:123], v[30:31]
    v_pk_add_f32 v[146:147], v[32:33], v[138:139]
    v_pk_add_f32 v[138:139], v[32:33], v[138:139] neg_lo:[0,1] neg_hi:[0,1]
    v_pk_mul_f32 v[26:27], v[52:53], v[132:133] op_sel_hi:[0,1]
    v_pk_mul_f32 v[28:29], v[52:53], v[132:133] op_sel:[1,0] op_sel_hi:[1,1]
    v_pk_fma_f32 v[26:27], v[52:53], v[148:149], v[26:27] op_sel:[1,0,0] op_sel_hi:[1,1,1]
    v_pk_fma_f32 v[28:29], v[52:53], v[148:149], v[28:29] op_sel_hi:[0,1,1] neg_lo:[1,0,0] neg_hi:[1,0,0]
    v_pk_add_f32 v[132:133], v[124:125], v[26:27] neg_lo:[0,1] neg_hi:[0,1]
    v_pk_add_f32 v[124:125], v[124:125], v[26:27]
    v_pk_add_f32 v[148:149], v[28:29], v[140:141]
    v_pk_add_f32 v[140:141], v[28:29], v[140:141] neg_lo:[0,1] neg_hi:[0,1]
    v_pk_mul_f32 v[30:31], v[52:53], v[134:135] op_sel_hi:[0,1]
    v_pk_mul_f32 v[32:33], v[52:53], v[134:135] op_sel:[1,0] op_sel_hi:[1,1]
    v_pk_fma_f32 v[30:31], v[52:53], v[150:151], v[30:31] op_sel:[1,0,0] op_sel_hi:[1,1,1]
    v_pk_fma_f32 v[32:33], v[52:53], v[150:151], v[32:33] op_sel_hi:[0,1,1] neg_lo:[1,0,0] neg_hi:[1,0,0]
    v_pk_add_f32 v[134:135], v[126:127], v[30:31] neg_lo:[0,1] neg_hi:[0,1]
    v_pk_add_f32 v[126:127], v[126:127], v[30:31]
    v_pk_add_f32 v[150:151], v[32:33], v[142:143]
    v_pk_add_f32 v[142:143], v[32:33], v[142:143] neg_lo:[0,1] neg_hi:[0,1]
    v_cvt_pk_bf16_f32 v152, v120, v121
    v_cvt_pk_bf16_f32 v153, v122, v123
    v_cvt_pk_bf16_f32 v154, v124, v125
    v_cvt_pk_bf16_f32 v155, v126, v127
    v_cvt_pk_bf16_f32 v156, v128, v129
    v_cvt_pk_bf16_f32 v157, v130, v131
    v_cvt_pk_bf16_f32 v158, v132, v133
    v_cvt_pk_bf16_f32 v159, v134, v135
    v_mfma_f32_16x16x32_bf16 v[200:203], v[40:43], v[152:155], 0
    v_mfma_f32_16x16x32_bf16 v[204:207], v[44:47], v[152:155], 0
    v_cvt_pk_bf16_f32 v160, v136, v137
    v_cvt_pk_bf16_f32 v161, v138, v139
    v_cvt_pk_bf16_f32 v162, v140, v141
    v_cvt_pk_bf16_f32 v163, v142, v143
    v_mfma_f32_16x16x32_bf16 v[208:211], v[40:43], v[156:159], 0
    v_mfma_f32_16x16x32_bf16 v[212:215], v[44:47], v[156:159], 0
    v_cvt_pk_bf16_f32 v164, v144, v145
    v_cvt_pk_bf16_f32 v165, v146, v147
    v_cvt_pk_bf16_f32 v166, v148, v149
    v_cvt_pk_bf16_f32 v167, v150, v151
    v_mfma_f32_16x16x32_bf16 v[216:219], v[40:43], v[160:163], 0
    v_mfma_f32_16x16x32_bf16 v[220:223], v[44:47], v[160:163], 0
    v_mfma_f32_16x16x32_bf16 v[224:227], v[40:43], v[164:167], 0
    v_mfma_f32_16x16x32_bf16 v[228:231], v[44:47], v[164:167], 0
    v_cvt_pk_bf16_f32 v168, v200, v204
    ds_write_b32 v5, v168 offset:512
    v_cvt_pk_bf16_f32 v169, v201, v205
    ds_write_b32 v5, v169 offset:5632
    v_cvt_pk_bf16_f32 v170, v202, v206
    ds_write_b32 v5, v170 offset:10752
    v_cvt_pk_bf16_f32 v171, v203, v207
    ds_write_b32 v5, v171 offset:15872
    v_cvt_pk_bf16_f32 v172, v208, v212
    ds_write_b32 v5, v172 offset:1792
    v_cvt_pk_bf16_f32 v173, v209, v213
    ds_write_b32 v5, v173 offset:6912
    v_cvt_pk_bf16_f32 v174, v210, v214
    ds_write_b32 v5, v174 offset:12032
    v_cvt_pk_bf16_f32 v175, v211, v215
    ds_write_b32 v5, v175 offset:17152
    v_cvt_pk_bf16_f32 v176, v216, v220
    ds_write_b32 v5, v176 offset:3072
    v_cvt_pk_bf16_f32 v177, v217, v221
    ds_write_b32 v5, v177 offset:8192
    v_cvt_pk_bf16_f32 v178, v218, v222
    ds_write_b32 v5, v178 offset:13312
    v_cvt_pk_bf16_f32 v179, v219, v223
    ds_write_b32 v5, v179 offset:18432
    v_cvt_pk_bf16_f32 v180, v224, v228
    ds_write_b32 v5, v180 offset:4352
    v_cvt_pk_bf16_f32 v181, v225, v229
    ds_write_b32 v5, v181 offset:9472
    v_cvt_pk_bf16_f32 v182, v226, v230
    ds_write_b32 v5, v182 offset:14592
    v_cvt_pk_bf16_f32 v183, v227, v231
    ds_write_b32 v5, v183 offset:19712
    s_waitcnt lgkmcnt(0)
    s_barrier
    s_branch A2
A1_U2:
    s_barrier
    ds_read_b128 v[152:155], v21 offset:0
    ds_read_b128 v[156:159], v22 offset:0
    ds_read_b128 v[160:163], v21 offset:16384
    ds_read_b128 v[164:167], v22 offset:16384
    ds_read_b128 v[200:203], v23 offset:32768
    ds_read_b128 v[204:207], v23 offset:34816
    ds_read_b128 v[208:211], v23 offset:36864
    ds_read_b128 v[212:215], v23 offset:38912
    s_waitcnt lgkmcnt(4)
    v_perm_b32 v168, v153, v152, s48
    v_perm_b32 v172, v153, v152, s49
    v_perm_b32 v169, v155, v154, s48
    v_perm_b32 v173, v155, v154, s49
    v_perm_b32 v170, v157, v156, s48
    v_perm_b32 v174, v157, v156, s49
    v_perm_b32 v171, v159, v158, s48
    v_perm_b32 v175, v159, v158, s49
    v_perm_b32 v176, v161, v160, s48
    v_perm_b32 v180, v161, v160, s49
    v_perm_b32 v177, v163, v162, s48
    v_perm_b32 v181, v163, v162, s49
    v_perm_b32 v178, v165, v164, s48
    v_perm_b32 v182, v165, v164, s49
    v_perm_b32 v179, v167, v166, s48
    v_perm_b32 v183, v167, v166, s49
    s_branch A1U2_MID
A1U2_LOOP:
    s_barrier
    v_mfma_f32_16x16x32_bf16 v[56:59], v[184:187], v[224:227], v[56:59]
    ds_read_b128 v[152:155], v21 offset:0
    v_mfma_f32_16x16x32_bf16 v[60:63], v[192:195], v[224:227], v[60:63]
    ds_read_b128 v[156:159], v22 offset:0
    v_mfma_f32_16x16x32_bf16 v[64:67], v[188:191], v[224:227], v[64:67]
    ds_read_b128 v[160:163], v21 offset:16384
    v_mfma_f32_16x16x32_bf16 v[68:71], v[196:199], v[224:227], v[68:71]
    ds_read_b128 v[164:167], v22 offset:16384
    v_mfma_f32_16x16x32_bf16 v[72:75], v[184:187], v[228:231], v[72:75]
    ds_read_b128 v[200:203], v23 offset:32768
    v_mfma_f32_16x16x32_bf16 v[76:79], v[192:195], v[228:231], v[76:79]
    ds_read_b128 v[204:207], v23 offset:34816
    v_mfma_f32_16x16x32_bf16 v[80:83], v[188:191], v[228:231], v[80:83]
    ds_read_b128 v[208:211], v23 offset:36864
    v_mfma_f32_16x16x32_bf16 v[84:87], v[196:199], v[228:231], v[84:87]
    ds_read_b128 v[212:215], v23 offset:38912
    s_waitcnt lgkmcnt(4)
    v_perm_b32 v168, v153, v152, s48
    v_perm_b32 v172, v153, v152, s49
    v_mfma_f32_16x16x32_bf16 v[88:91], v[184:187], v[232:235], v[88:91]
    v_perm_b32 v169, v155, v154, s48
    v_perm_b32 v173, v155, v154, s49
    v_mfma_f32_16x16x32_bf16 v[92:95], v[192:195], v[232:235], v[92:95]
    v_perm_b32 v170, v157, v156, s48
    v_perm_b32 v174, v157, v156, s49
    v_mfma_f32_16x16x32_bf16 v[96:99], v[188:191], v[232:235], v[96:99]
    v_perm_b32 v171, v159, v158, s48
    v_perm_b32 v175, v159, v158, s49
    v_mfma_f32_16x16x32_bf16 v[100:103], v[196:199], v[232:235], v[100:103]
    v_perm_b32 v176, v161, v160, s48
    v_perm_b32 v180, v161, v160, s49
    v_mfma_f32_16x16x32_bf16 v[104:107], v[184:187], v[236:239], v[104:107]
    v_perm_b32 v177, v163, v162, s48
    v_perm_b32 v181, v163, v162, s49
    v_mfma_f32_16x16x32_bf16 v[108:111], v[192:195], v[236:239], v[108:111]
    v_perm_b32 v178, v165, v164, s48
    v_perm_b32 v182, v165, v164, s49
    v_mfma_f32_16x16x32_bf16 v[112:115], v[188:191], v[236:239], v[112:115]
    v_perm_b32 v179, v167, v166, s48
    v_mfma_f32_16x16x32_bf16 v[116:119], v[196:199], v[236:239], v[116:119]
    v_perm_b32 v183, v167, v166, s49
A1U2_MID:
    s_waitcnt lgkmcnt(0)
    v_mfma_f32_16x16x32_bf16 v[56:59], v[168:171], v[200:203], v[56:59]
    ds_read_b128 v[152:155], v13 offset:0
    v_mfma_f32_16x16x32_bf16 v[60:63], v[176:179], v[200:203], v[60:63]
    ds_read_b128 v[156:159], v14 offset:0
    v_mfma_f32_16x16x32_bf16 v[64:67], v[172:175], v[200:203], v[64:67]
    ds_read_b128 v[160:163], v13 offset:16384
    v_mfma_f32_16x16x32_bf16 v[68:71], v[180:183], v[200:203], v[68:71]
    ds_read_b128 v[164:167], v14 offset:16384
    v_mfma_f32_16x16x32_bf16 v[72:75], v[168:171], v[204:207], v[72:75]
    ds_read_b128 v[224:227], v24 offset:32768
    v_mfma_f32_16x16x32_bf16 v[76:79], v[176:179], v[204:207], v[76:79]
    ds_read_b128 v[228:231], v24 offset:34816
    v_mfma_f32_16x16x32_bf16 v[80:83], v[172:175], v[204:207], v[80:83]
    ds_read_b128 v[232:235], v24 offset:36864
    v_mfma_f32_16x16x32_bf16 v[84:87], v[180:183], v[204:207], v[84:87]
    ds_read_b128 v[236:239], v24 offset:38912
    s_waitcnt lgkmcnt(4)
    v_perm_b32 v184, v153, v152, s48
    v_perm_b32 v188, v153, v152, s49
    v_mfma_f32_16x16x32_bf16 v[88:91], v[168:171], v[208:211], v[88:91]
    v_perm_b32 v185, v155, v154, s48
    v_perm_b32 v189, v155, v154, s49
    v_mfma_f32_16x16x32_bf16 v[92:95], v[176:179], v[208:211], v[92:95]
    v_perm_b32 v186, v157, v156, s48
    v_perm_b32 v190, v157, v156, s49
    v_mfma_f32_16x16x32_bf16 v[96:99], v[172:175], v[208:211], v[96:99]
    v_add_u32 v21, s43, v17
    v_add_u32 v22, s43, v18
    v_perm_b32 v187, v159, v158, s48
    v_perm_b32 v191, v159, v158, s49
    v_mfma_f32_16x16x32_bf16 v[100:103], v[180:183], v[208:211], v[100:103]
    v_add_u32 v23, s43, v19
    v_add_u32 v24, s43, v20
    v_add_u32 v13, s43, v15
    v_add_u32 v14, s43, v16
    v_perm_b32 v192, v161, v160, s48
    v_perm_b32 v196, v161, v160, s49
    v_mfma_f32_16x16x32_bf16 v[104:107], v[168:171], v[212:215], v[104:107]
    s_add_u32 s43, s43, 53248
    s_cmp_eq_u32 s43, 159744
    v_perm_b32 v193, v163, v162, s48
    v_perm_b32 v197, v163, v162, s49
    v_mfma_f32_16x16x32_bf16 v[108:111], v[176:179], v[212:215], v[108:111]
    s_cselect_b32 s43, 0, s43
    s_add_u32 s42, s42, 1
    v_perm_b32 v194, v165, v164, s48
    v_perm_b32 v198, v165, v164, s49
    v_mfma_f32_16x16x32_bf16 v[112:115], v[172:175], v[212:215], v[112:115]
    s_cmp_lt_u32 s42, 5
    v_perm_b32 v195, v167, v166, s48
    v_mfma_f32_16x16x32_bf16 v[116:119], v[180:183], v[212:215], v[116:119]
    v_perm_b32 v199, v167, v166, s49
    s_waitcnt lgkmcnt(0)
    s_cbranch_scc1 A1U2_LOOP
    v_mfma_f32_16x16x32_bf16 v[56:59], v[184:187], v[224:227], v[56:59]
    v_mfma_f32_16x16x32_bf16 v[60:63], v[192:195], v[224:227], v[60:63]
    v_mfma_f32_16x16x32_bf16 v[64:67], v[188:191], v[224:227], v[64:67]
    v_mfma_f32_16x16x32_bf16 v[68:71], v[196:199], v[224:227], v[68:71]
    v_mfma_f32_16x16x32_bf16 v[72:75], v[184:187], v[228:231], v[72:75]
    v_mfma_f32_16x16x32_bf16 v[76:79], v[192:195], v[228:231], v[76:79]
    v_mfma_f32_16x16x32_bf16 v[80:83], v[188:191], v[228:231], v[80:83]
    v_mfma_f32_16x16x32_bf16 v[84:87], v[196:199], v[228:231], v[84:87]
    v_mfma_f32_16x16x32_bf16 v[88:91], v[184:187], v[232:235], v[88:91]
    v_mfma_f32_16x16x32_bf16 v[92:95], v[192:195], v[232:235], v[92:95]
    v_mfma_f32_16x16x32_bf16 v[96:99], v[188:191], v[232:235], v[96:99]
    v_mfma_f32_16x16x32_bf16 v[100:103], v[196:199], v[232:235], v[100:103]
    v_mfma_f32_16x16x32_bf16 v[104:107], v[184:187], v[236:239], v[104:107]
    v_mfma_f32_16x16x32_bf16 v[108:111], v[192:195], v[236:239], v[108:111]
    v_mfma_f32_16x16x32_bf16 v[112:115], v[188:191], v[236:239], v[112:115]
    v_mfma_f32_16x16x32_bf16 v[116:119], v[196:199], v[236:239], v[116:119]
    v_pk_mul_f32 v[26:27], v[48:49], v[64:65] op_sel_hi:[0,1]
    v_pk_mul_f32 v[28:29], v[48:49], v[64:65] op_sel:[1,0] op_sel_hi:[1,1]
    v_pk_fma_f32 v[26:27], v[48:49], v[80:81], v[26:27] op_sel:[1,0,0] op_sel_hi:[1,1,1]
    v_pk_fma_f32 v[28:29], v[48:49], v[80:81], v[28:29] op_sel_hi:[0,1,1] neg_lo:[1,0,0] neg_hi:[1,0,0]
    v_pk_add_f32 v[64:65], v[56:57], v[26:27] neg_lo:[0,1] neg_hi:[0,1]
    v_pk_add_f32 v[56:57], v[56:57], v[26:27]
    v_pk_add_f32 v[80:81], v[28:29], v[72:73]
    v_pk_add_f32 v[72:73], v[28:29], v[72:73] neg_lo:[0,1] neg_hi:[0,1]
    v_pk_mul_f32 v[30:31], v[48:49], v[66:67] op_sel_hi:[0,1]
    v_pk_mul_f32 v[32:33], v[48:49], v[66:67] op_sel:[1,0] op_sel_hi:[1,1]
    v_pk_fma_f32 v[30:31], v[48:49], v[82:83], v[30:31] op_sel:[1,0,0] op_sel_hi:[1,1,1]
    v_pk_fma_f32 v[32:33], v[48:49], v[82:83], v[32:33] op_sel_hi:[0,1,1] neg_lo:[1,0,0] neg_hi:[1,0,0]
    v_pk_add_f32 v[66:67], v[58:59], v[30:31] neg_lo:[0,1] neg_hi:[0,1]
    v_pk_add_f32 v[58:59], v[58:59], v[30:31]
    v_pk_add_f32 v[82:83], v[32:33], v[74:75]
    v_pk_add_f32 v[74:75], v[32:33], v[74:75] neg_lo:[0,1] neg_hi:[0,1]
    v_pk_mul_f32 v[26:27], v[48:49], v[68:69] op_sel_hi:[0,1]
    v_pk_mul_f32 v[28:29], v[48:49], v[68:69] op_sel:[1,0] op_sel_hi:[1,1]
    v_pk_fma_f32 v[26:27], v[48:49], v[84:85], v[26:27] op_sel:[1,0,0] op_sel_hi:[1,1,1]
    v_pk_fma_f32 v[28:29], v[48:49], v[84:85], v[28:29] op_sel_hi:[0,1,1] neg_lo:[1,0,0] neg_hi:[1,0,0]
    v_pk_add_f32 v[68:69], v[60:61], v[26:27] neg_lo:[0,1] neg_hi:[0,1]
    v_pk_add_f32 v[60:61], v[60:61], v[26:27]
    v_pk_add_f32 v[84:85], v[28:29], v[76:77]
    v_pk_add_f32 v[76:77], v[28:29], v[76:77] neg_lo:[0,1] neg_hi:[0,1]
    v_pk_mul_f32 v[30:31], v[48:49], v[70:71] op_sel_hi:[0,1]
    v_pk_mul_f32 v[32:33], v[48:49], v[70:71] op_sel:[1,0] op_sel_hi:[1,1]
    v_pk_fma_f32 v[30:31], v[48:49], v[86:87], v[30:31] op_sel:[1,0,0] op_sel_hi:[1,1,1]
    v_pk_fma_f32 v[32:33], v[48:49], v[86:87], v[32:33] op_sel_hi:[0,1,1] neg_lo:[1,0,0] neg_hi:[1,0,0]
    v_pk_add_f32 v[70:71], v[62:63], v[30:31] neg_lo:[0,1] neg_hi:[0,1]
    v_pk_add_f32 v[62:63], v[62:63], v[30:31]
    v_pk_add_f32 v[86:87], v[32:33], v[78:79]
    v_pk_add_f32 v[78:79], v[32:33], v[78:79] neg_lo:[0,1] neg_hi:[0,1]
    v_cvt_pk_bf16_f32 v152, v56, v57
    v_cvt_pk_bf16_f32 v153, v58, v59
    v_cvt_pk_bf16_f32 v154, v60, v61
    v_cvt_pk_bf16_f32 v155, v62, v63
    v_cvt_pk_bf16_f32 v156, v64, v65
    v_cvt_pk_bf16_f32 v157, v66, v67
    v_cvt_pk_bf16_f32 v158, v68, v69
    v_cvt_pk_bf16_f32 v159, v70, v71
    v_mfma_f32_16x16x32_bf16 v[200:203], v[40:43], v[152:155], 0
    v_mfma_f32_16x16x32_bf16 v[204:207], v[44:47], v[152:155], 0
    v_cvt_pk_bf16_f32 v160, v72, v73
    v_cvt_pk_bf16_f32 v161, v74, v75
    v_cvt_pk_bf16_f32 v162, v76, v77
    v_cvt_pk_bf16_f32 v163, v78, v79
    v_mfma_f32_16x16x32_bf16 v[208:211], v[40:43], v[156:159], 0
    v_mfma_f32_16x16x32_bf16 v[212:215], v[44:47], v[156:159], 0
    v_cvt_pk_bf16_f32 v164, v80, v81
    v_cvt_pk_bf16_f32 v165, v82, v83
    v_cvt_pk_bf16_f32 v166, v84, v85
    v_cvt_pk_bf16_f32 v167, v86, v87
    v_mfma_f32_16x16x32_bf16 v[216:219], v[40:43], v[160:163], 0
    v_mfma_f32_16x16x32_bf16 v[220:223], v[44:47], v[160:163], 0
    v_mfma_f32_16x16x32_bf16 v[224:227], v[40:43], v[164:167], 0
    v_mfma_f32_16x16x32_bf16 v[228:231], v[44:47], v[164:167], 0
    v_cvt_pk_bf16_f32 v168, v200, v204
    ds_write_b32 v5, v168 offset:0
    v_cvt_pk_bf16_f32 v169, v201, v205
    ds_write_b32 v5, v169 offset:5120
    v_cvt_pk_bf16_f32 v170, v202, v206
    ds_write_b32 v5, v170 offset:10240
    v_cvt_pk_bf16_f32 v171, v203, v207
    ds_write_b32 v5, v171 offset:15360
    v_cvt_pk_bf16_f32 v172, v208, v212
    ds_write_b32 v5, v172 offset:1280
    v_cvt_pk_bf16_f32 v173, v209, v213
    ds_write_b32 v5, v173 offset:6400
    v_cvt_pk_bf16_f32 v174, v210, v214
    ds_write_b32 v5, v174 offset:11520
    v_cvt_pk_bf16_f32 v175, v211, v215
    ds_write_b32 v5, v175 offset:16640
    v_cvt_pk_bf16_f32 v176, v216, v220
    ds_write_b32 v5, v176 offset:2560
    v_cvt_pk_bf16_f32 v177, v217, v221
    ds_write_b32 v5, v177 offset:7680
    v_cvt_pk_bf16_f32 v178, v218, v222
    ds_write_b32 v5, v178 offset:12800
    v_cvt_pk_bf16_f32 v179, v219, v223
    ds_write_b32 v5, v179 offset:17920
    v_cvt_pk_bf16_f32 v180, v224, v228
    ds_write_b32 v5, v180 offset:3840
    v_cvt_pk_bf16_f32 v181, v225, v229
    ds_write_b32 v5, v181 offset:8960
    v_cvt_pk_bf16_f32 v182, v226, v230
    ds_write_b32 v5, v182 offset:14080
    v_cvt_pk_bf16_f32 v183, v227, v231
    ds_write_b32 v5, v183 offset:19200
    s_waitcnt lgkmcnt(0)
    s_barrier
    v_pk_mul_f32 v[26:27], v[50:51], v[96:97] op_sel_hi:[0,1]
    v_pk_mul_f32 v[28:29], v[50:51], v[96:97] op_sel:[1,0] op_sel_hi:[1,1]
    v_pk_fma_f32 v[26:27], v[50:51], v[112:113], v[26:27] op_sel:[1,0,0] op_sel_hi:[1,1,1]
    v_pk_fma_f32 v[28:29], v[50:51], v[112:113], v[28:29] op_sel_hi:[0,1,1] neg_lo:[1,0,0] neg_hi:[1,0,0]
    v_pk_add_f32 v[96:97], v[88:89], v[26:27] neg_lo:[0,1] neg_hi:[0,1]
    v_pk_add_f32 v[88:89], v[88:89], v[26:27]
    v_pk_add_f32 v[112:113], v[28:29], v[104:105]
    v_pk_add_f32 v[104:105], v[28:29], v[104:105] neg_lo:[0,1] neg_hi:[0,1]
    v_pk_mul_f32 v[30:31], v[50:51], v[98:99] op_sel_hi:[0,1]
    v_pk_mul_f32 v[32:33], v[50:51], v[98:99] op_sel:[1,0] op_sel_hi:[1,1]
    v_pk_fma_f32 v[30:31], v[50:51], v[114:115], v[30:31] op_sel:[1,0,0] op_sel_hi:[1,1,1]
    v_pk_fma_f32 v[32:33], v[50:51], v[114:115], v[32:33] op_sel_hi:[0,1,1] neg_lo:[1,0,0] neg_hi:[1,0,0]
    v_pk_add_f32 v[98:99], v[90:91], v[30:31] neg_lo:[0,1] neg_hi:[0,1]
    v_pk_add_f32 v[90:91], v[90:91], v[30:31]
    v_pk_add_f32 v[114:115], v[32:33], v[106:107]
    v_pk_add_f32 v[106:107], v[32:33], v[106:107] neg_lo:[0,1] neg_hi:[0,1]
    v_pk_mul_f32 v[26:27], v[50:51], v[100:101] op_sel_hi:[0,1]
    v_pk_mul_f32 v[28:29], v[50:51], v[100:101] op_sel:[1,0] op_sel_hi:[1,1]
    v_pk_fma_f32 v[26:27], v[50:51], v[116:117], v[26:27] op_sel:[1,0,0] op_sel_hi:[1,1,1]
    v_pk_fma_f32 v[28:29], v[50:51], v[116:117], v[28:29] op_sel_hi:[0,1,1] neg_lo:[1,0,0] neg_hi:[1,0,0]
    v_pk_add_f32 v[100:101], v[92:93], v[26:27] neg_lo:[0,1] neg_hi:[0,1]
    v_pk_add_f32 v[92:93], v[92:93], v[26:27]
    v_pk_add_f32 v[116:117], v[28:29], v[108:109]
    v_pk_add_f32 v[108:109], v[28:29], v[108:109] neg_lo:[0,1] neg_hi:[0,1]
    v_pk_mul_f32 v[30:31], v[50:51], v[102:103] op_sel_hi:[0,1]
    v_pk_mul_f32 v[32:33], v[50:51], v[102:103] op_sel:[1,0] op_sel_hi:[1,1]
    v_pk_fma_f32 v[30:31], v[50:51], v[118:119], v[30:31] op_sel:[1,0,0] op_sel_hi:[1,1,1]
    v_pk_fma_f32 v[32:33], v[50:51], v[118:119], v[32:33] op_sel_hi:[0,1,1] neg_lo:[1,0,0] neg_hi:[1,0,0]
    v_pk_add_f32 v[102:103], v[94:95], v[30:31] neg_lo:[0,1] neg_hi:[0,1]
    v_pk_add_f32 v[94:95], v[94:95], v[30:31]
    v_pk_add_f32 v[118:119], v[32:33], v[110:111]
    v_pk_add_f32 v[110:111], v[32:33], v[110:111] neg_lo:[0,1] neg_hi:[0,1]
    v_cvt_pk_bf16_f32 v152, v88, v89
    v_cvt_pk_bf16_f32 v153, v90, v91
    v_cvt_pk_bf16_f32 v154, v92, v93
    v_cvt_pk_bf16_f32 v155, v94, v95
    v_cvt_pk_bf16_f32 v156, v96, v97
    v_cvt_pk_bf16_f32 v157, v98, v99
    v_cvt_pk_bf16_f32 v158, v100, v101
    v_cvt_pk_bf16_f32 v159, v102, v103
    v_mfma_f32_16x16x32_bf16 v[200:203], v[40:43], v[152:155], 0
    v_mfma_f32_16x16x32_bf16 v[204:207], v[44:47], v[152:155], 0
    v_cvt_pk_bf16_f32 v160, v104, v105
    v_cvt_pk_bf16_f32 v161, v106, v107
    v_cvt_pk_bf16_f32 v162, v108, v109
    v_cvt_pk_bf16_f32 v163, v110, v111
    v_mfma_f32_16x16x32_bf16 v[208:211], v[40:43], v[156:159], 0
    v_mfma_f32_16x16x32_bf16 v[212:215], v[44:47], v[156:159], 0
    v_cvt_pk_bf16_f32 v164, v112, v113
    v_cvt_pk_bf16_f32 v165, v114, v115
    v_cvt_pk_bf16_f32 v166, v116, v117
    v_cvt_pk_bf16_f32 v167, v118, v119
    v_mfma_f32_16x16x32_bf16 v[216:219], v[40:43], v[160:163], 0
    v_mfma_f32_16x16x32_bf16 v[220:223], v[44:47], v[160:163], 0
    v_mfma_f32_16x16x32_bf16 v[224:227], v[40:43], v[164:167], 0
    v_mfma_f32_16x16x32_bf16 v[228:231], v[44:47], v[164:167], 0
    v_cvt_pk_bf16_f32 v168, v200, v204
    ds_write_b32 v5, v168 offset:256
    v_cvt_pk_bf16_f32 v169, v201, v205
    ds_write_b32 v5, v169 offset:5376
    v_cvt_pk_bf16_f32 v170, v202, v206
    ds_write_b32 v5, v170 offset:10496
    v_cvt_pk_bf16_f32 v171, v203, v207
    ds_write_b32 v5, v171 offset:15616
    v_cvt_pk_bf16_f32 v172, v208, v212
    ds_write_b32 v5, v172 offset:1536
    v_cvt_pk_bf16_f32 v173, v209, v213
    ds_write_b32 v5, v173 offset:6656
    v_cvt_pk_bf16_f32 v174, v210, v214
    ds_write_b32 v5, v174 offset:11776
    v_cvt_pk_bf16_f32 v175, v211, v215
    ds_write_b32 v5, v175 offset:16896
    v_cvt_pk_bf16_f32 v176, v216, v220
    ds_write_b32 v5, v176 offset:2816
    v_cvt_pk_bf16_f32 v177, v217, v221
    ds_write_b32 v5, v177 offset:7936
    v_cvt_pk_bf16_f32 v178, v218, v222
    ds_write_b32 v5, v178 offset:13056
    v_cvt_pk_bf16_f32 v179, v219, v223
    ds_write_b32 v5, v179 offset:18176
    v_cvt_pk_bf16_f32 v180, v224, v228
    ds_write_b32 v5, v180 offset:4096
    v_cvt_pk_bf16_f32 v181, v225, v229
    ds_write_b32 v5, v181 offset:9216
    v_cvt_pk_bf16_f32 v182, v226, v230
    ds_write_b32 v5, v182 offset:14336
    v_cvt_pk_bf16_f32 v183, v227, v231
    ds_write_b32 v5, v183 offset:19456
    s_waitcnt lgkmcnt(0)
    s_barrier
A2:
    v_lshrrev_b32 v6, 4, v0
    s_mul_i32 s21, s18, 5
    s_min_u32 s22, s16, 4
    s_add_u32 s21, s21, s22
    s_lshl_b32 s21, s21, 5
    v_and_b32 v7, 31, v0
    v_add_u32 v8, s21, v7
    v_sub_u32 v9, 640, v8
    v_min_u32 v8, v8, v9
    s_movk_i32 s22, 160
    v_cmp_lt_u32 vcc, s22, v8
    v_sub_u32 v9, 480, v8
    s_nop 0
    v_cndmask_b32 v9, v8, v9, vcc
    v_add_u32 v10, 320, v9
    v_cmp_eq_u32 vcc, s22, v8
    v_mov_b32 v11, 320
    v_mov_b32 v12, 480
    v_cndmask_b32 v9, v9, v11, vcc
    v_cndmask_b32 v10, v10, v12, vcc
    v_lshrrev_b32 v12, 5, v0
    v_mul_u32_u24 v13, 81920, v12
    v_lshl_add_u32 v1, v9, 4, v13
    v_lshl_add_u32 v10, v10, 4, v13
    v_cmp_eq_u32 vcc, 0, v8
    v_cmp_eq_u32 s[40:41], v11, v8
    s_nop 0
    s_or_b64 vcc, vcc, s[40:41]
    v_mov_b32 v13, 1073741824
    v_cndmask_b32 v249, v10, v13, vcc
    s_cmp_ge_u32 s18, 2
    s_cselect_b32 s42, 0x80008000, 0
    s_mul_i32 s22, s17, 163840
    s_add_u32 s22, s22, 2621440
    s_mov_b32 s36, s76
    s_mov_b32 s37, s77
    s_mov_b32 s38, 5242880
    s_mov_b32 s39, 0x20000
    s_cmp_lg_u32 s17, 0
    s_cselect_b32 s43, 10, 1
    s_cselect_b32 s44, 0, 22528
    s_cselect_b32 s45, 0x80008000, s42
    s_cselect_b32 s23, 0, s42
    s_cselect_b32 s46, 1.0, 0
    s_cselect_b64 s[12:13], 0, -1
    s_xor_b32 s45, s45, s42
    s_lshl_b32 s43, s43, 11
    v_bfe_u32 v13, v0, 1, 3
    v_lshlrev_b32 v14, 2, v12
    v_xor_b32 v13, v13, v14
    s_lshr_b32 s50, s16, 1
    v_xor_b32 v13, s50, v13
    v_lshlrev_b32 v13, 4, v13
    v_and_b32 v14, 15, v0
    v_lshl_add_u32 v13, v14, 7, v13
    v_bfe_u32 v9, v0, 4, 1
    v_mul_u32_u24 v9, 5120, v9
    s_and_b32 s50, s16, 1
    s_mul_i32 s50, s50, 10240
    s_add_u32 s50, s50, 53248
    v_add3_u32 v13, v13, v9, s50
    v_add_u32 v3, s43, v13
    v_add_u32 v8, s44, v13
    v_lshlrev_b32 v2, 4, v0
    s_and_b32 s50, s16, 1
    s_lshl_b32 s50, s50, 2
    s_lshr_b32 s51, s16, 1
    s_add_u32 s50, s50, s51
    s_lshl_b32 s50, s50, 11
    s_add_u32 s50, s50, 106496
    v_add_u32 v11, s50, v2
    s_cmp_eq_u32 s16, 4
    s_cselect_b32 s50, 98304, 0
    s_cselect_b32 s51, 0, 10496
    s_cmp_lg_u32 s16, 4
    s_cselect_b32 s50, 106496, s50
    v_add_u32 v2, s50, v2
    v_mul_u32_u24 v9, 328, v7
    v_lshl_add_u32 v9, v12, 3, v9
    s_min_u32 s50, s16, 4
    s_lshl_b32 s50, s50, 6
    s_add_u32 s50, s50, s51
    v_add_u32 v9, s50, v9
    s_cmp_lt_u32 s16, 4
    s_cselect_b32 s50, 0, 0x40000
    v_add_u32 v10, s50, v9
    s_sub_u32 s50, 2048, s17
    s_cmp_lg_u32 s17, 0
    s_cselect_b32 s50, s50, 16
    s_cselect_b32 s51, -32, 32
    s_cmp_ge_u32 s16, 4
    s_cselect_b32 s50, s50, s17
    s_cselect_b32 s51, s51, 32
    s_lshl_b32 s56, s19, 4
    s_mul_i32 s56, s56, s51
    s_add_u32 s50, s50, s56
    s_add_u32 s56, s16, 2
    s_mul_i32 s56, s56, 5248
    s_movk_i32 s57, 328
    v_add_u32 v4, 0, v0
    v_mul_u32_u24 v5, 205, v4
    v_lshrrev_b32 v5, 12, v5
    v_mul_u32_u24 v14, 20, v5
    v_sub_u32 v4, v4, v14
    v_lshlrev_b32 v4, 4, v4
    v_mad_u32_u24 v14, v5, s57, v4
    v_add_u32 v238, s56, v14
    v_mul_i32_i24 v5, s51, v5
    v_add_u32 v5, s50, v5
    v_mul_u32_u24 v5, 2560, v5
    v_add_u32 v243, v5, v4
    v_add_u32 v4, 64, v0
    v_mul_u32_u24 v5, 205, v4
    v_lshrrev_b32 v5, 12, v5
    v_mul_u32_u24 v14, 20, v5
    v_sub_u32 v4, v4, v14
    v_lshlrev_b32 v4, 4, v4
    v_mad_u32_u24 v14, v5, s57, v4
    v_add_u32 v239, s56, v14
    v_mul_i32_i24 v5, s51, v5
    v_add_u32 v5, s50, v5
    v_mul_u32_u24 v5, 2560, v5
    v_add_u32 v244, v5, v4
    v_add_u32 v4, 128, v0
    v_mul_u32_u24 v5, 205, v4
    v_lshrrev_b32 v5, 12, v5
    v_mul_u32_u24 v14, 20, v5
    v_sub_u32 v4, v4, v14
    v_lshlrev_b32 v4, 4, v4
    v_mad_u32_u24 v14, v5, s57, v4
    v_add_u32 v240, s56, v14
    v_mul_i32_i24 v5, s51, v5
    v_add_u32 v5, s50, v5
    v_mul_u32_u24 v5, 2560, v5
    v_add_u32 v245, v5, v4
    v_add_u32 v4, 192, v0
    v_mul_u32_u24 v5, 205, v4
    v_lshrrev_b32 v5, 12, v5
    v_mul_u32_u24 v14, 20, v5
    v_sub_u32 v4, v4, v14
    v_lshlrev_b32 v4, 4, v4
    v_mad_u32_u24 v14, v5, s57, v4
    v_add_u32 v241, s56, v14
    v_mul_i32_i24 v5, s51, v5
    v_add_u32 v5, s50, v5
    v_mul_u32_u24 v5, 2560, v5
    v_add_u32 v246, v5, v4
    v_add_u32 v4, 256, v0
    v_mul_u32_u24 v5, 205, v4
    v_lshrrev_b32 v5, 12, v5
    v_mul_u32_u24 v14, 20, v5
    v_sub_u32 v4, v4, v14
    v_lshlrev_b32 v4, 4, v4
    v_mad_u32_u24 v14, v5, s57, v4
    v_add_u32 v242, s56, v14
    v_mul_i32_i24 v5, s51, v5
    v_add_u32 v5, s50, v5
    v_mul_u32_u24 v5, 2560, v5
    v_add_u32 v247, v5, v4
    s_lshl_b32 s8, s17, 2
    s_add_u32 s8, s8, s18
    s_lshl_b32 s8, s8, 6
    s_add_u32 s8, s8, 5275648
    v_lshl_add_u32 v4, v0, 12, s8
    v_mov_b32 v5, 1073741824
    v_cmp_gt_u32 vcc, 8, v0
    s_nop 1
    v_cndmask_b32 v254, v5, v4, vcc
    s_mul_i32 s56, s18, 320
    s_lshl_b32 s50, s58, 12
    s_add_u32 s50, s50, 5275648
    v_lshl_add_u32 v15, v0, 6, s50
    s_waitcnt vmcnt(0) lgkmcnt(0)
    s_barrier
    v_mov_b32 v14, 163824
    ds_read_b32 v252, v14
    s_waitcnt lgkmcnt(0)
    v_xor_b32 v253, 0x5bd1e995, v252
    s_cmp_lg_u32 s16, 6
    s_cbranch_scc1 A2_NOFLAG
    buffer_store_dwordx2 v[252:253], v254, s[32:35], 0 offen sc1
A2_NOFLAG:
    ds_read_b128 v[144:147], v13
    ds_read_b128 v[148:151], v13 offset:20480
    ds_read_b128 v[152:155], v3
    ds_read_b128 v[156:159], v8
    s_waitcnt lgkmcnt(2)
    v_xor_b32 v148, s23, v148
    v_xor_b32 v149, s23, v149
    v_xor_b32 v150, s23, v150
    v_xor_b32 v151, s23, v151
    v_perm_b32 v176, v148, v144, s48
    v_perm_b32 v177, v148, v144, s49
    v_perm_b32 v178, v149, v145, s48
    v_perm_b32 v179, v149, v145, s49
    v_perm_b32 v180, v150, v146, s48
    v_perm_b32 v181, v150, v146, s49
    v_perm_b32 v182, v151, v147, s48
    v_perm_b32 v183, v151, v147, s49
    ds_write_b128 v11, v[176:179] offset:0
    ds_write_b128 v11, v[180:183] offset:1024
    s_waitcnt lgkmcnt(2)
    v_xor_b32 v152, s45, v152
    v_xor_b32 v156, s42, v156
    v_xor_b32 v153, s45, v153
    v_xor_b32 v157, s42, v157
    v_xor_b32 v154, s45, v154
    v_xor_b32 v158, s42, v158
    v_xor_b32 v155, s45, v155
    v_xor_b32 v159, s42, v159
    v_perm_b32 v184, v156, v152, s48
    v_perm_b32 v185, v156, v152, s49
    v_perm_b32 v186, v157, v153, s48
    v_perm_b32 v187, v157, v153, s49
    v_perm_b32 v188, v158, v154, s48
    v_perm_b32 v189, v158, v154, s49
    v_perm_b32 v190, v159, v155, s48
    v_perm_b32 v191, v159, v155, s49
    ds_write_b128 v11, v[184:187] offset:16384
    ds_write_b128 v11, v[188:191] offset:17408
    s_cmp_lg_u32 s16, 0
    s_cbranch_scc1 A2_SEEN
    s_mov_b32 s4, 0
A2_POLL:
    buffer_load_dwordx2 v[250:251], v15, s[32:35], 0 offen sc1
    s_waitcnt vmcnt(0)
    v_cmp_ne_u32 vcc, v250, v252
    v_cmp_ne_u32 s[6:7], v251, v253
    s_nop 0
    s_or_b64 vcc, vcc, s[6:7]
    s_cbranch_vccz A2_SEEN
    s_add_u32 s4, s4, 1
    s_sleep 2
    s_cmp_lt_u32 s4, 0x40000
    s_cbranch_scc1 A2_POLL
A2_SEEN:
    s_waitcnt lgkmcnt(0)
    s_barrier
    s_cmp_ge_u32 s16, 6
    s_cbranch_scc1 A2_OUT
    s_mov_b64 vcc, s[12:13]
    buffer_load_dwordx4 v[16:19], v1, s[32:35], s22 offen sc1
    buffer_load_dwordx4 v[48:51], v249, s[32:35], s22 offen sc1
    s_add_u32 s22, s22, 10240
    buffer_load_dwordx4 v[20:23], v1, s[32:35], s22 offen sc1
    buffer_load_dwordx4 v[52:55], v249, s[32:35], s22 offen sc1
    s_add_u32 s22, s22, 10240
    buffer_load_dwordx4 v[24:27], v1, s[32:35], s22 offen sc1
    buffer_load_dwordx4 v[56:59], v249, s[32:35], s22 offen sc1
    s_add_u32 s22, s22, 10240
    buffer_load_dwordx4 v[28:31], v1, s[32:35], s22 offen sc1
    buffer_load_dwordx4 v[60:63], v249, s[32:35], s22 offen sc1
    s_add_u32 s22, s22, 10240
    buffer_load_dwordx4 v[32:35], v1, s[32:35], s22 offen sc1
    buffer_load_dwordx4 v[64:67], v249, s[32:35], s22 offen sc1
    s_add_u32 s22, s22, 10240
    buffer_load_dwordx4 v[36:39], v1, s[32:35], s22 offen sc1
    buffer_load_dwordx4 v[68:71], v249, s[32:35], s22 offen sc1
    s_add_u32 s22, s22, 10240
    buffer_load_dwordx4 v[40:43], v1, s[32:35], s22 offen sc1
    buffer_load_dwordx4 v[72:75], v249, s[32:35], s22 offen sc1
    s_add_u32 s22, s22, 10240
    buffer_load_dwordx4 v[44:47], v1, s[32:35], s22 offen sc1
    buffer_load_dwordx4 v[76:79], v249, s[32:35], s22 offen sc1
    s_cmp_ge_u32 s16, 4
    s_cbranch_scc1 A2_HALF
    ds_read_b128 v[144:147], v2 offset:0
    ds_read_b128 v[148:151], v2 offset:1024
    ds_read_b128 v[152:155], v2 offset:16384
    ds_read_b128 v[156:159], v2 offset:17408
    ds_read_b128 v[160:163], v2 offset:2048
    ds_read_b128 v[164:167], v2 offset:3072
    ds_read_b128 v[168:171], v2 offset:18432
    ds_read_b128 v[172:175], v2 offset:19456
    s_waitcnt vmcnt(12)
    s_cbranch_vccz A2_NP00
    v_perm_b32 v14, v48, v16, s49
    v_perm_b32 v16, v48, v16, s48
    v_mov_b32 v48, v14
    v_perm_b32 v14, v49, v17, s49
    v_perm_b32 v17, v49, v17, s48
    v_mov_b32 v49, v14
    v_perm_b32 v14, v50, v18, s49
    v_perm_b32 v18, v50, v18, s48
    v_mov_b32 v50, v14
    v_perm_b32 v14, v51, v19, s49
    v_perm_b32 v19, v51, v19, s48
    v_mov_b32 v51, v14
    v_perm_b32 v14, v52, v20, s49
    v_perm_b32 v20, v52, v20, s48
    v_mov_b32 v52, v14
    v_perm_b32 v14, v53, v21, s49
    v_perm_b32 v21, v53, v21, s48
    v_mov_b32 v53, v14
    v_perm_b32 v14, v54, v22, s49
    v_perm_b32 v22, v54, v22, s48
    v_mov_b32 v54, v14
    v_perm_b32 v14, v55, v23, s49
    v_perm_b32 v23, v55, v23, s48
    v_mov_b32 v55, v14
A2_NP00:
    s_waitcnt lgkmcnt(4)
    v_mfma_f32_32x32x16_bf16 v[80:95], v[16:19], v[144:147], 0
    v_mfma_f32_32x32x16_bf16 v[112:127], v[48:51], v[152:155], 0
    v_mfma_f32_32x32x16_bf16 v[80:95], v[20:23], v[148:151], v[80:95]
    v_mfma_f32_32x32x16_bf16 v[112:127], v[52:55], v[156:159], v[112:127]
    ds_read_b128 v[144:147], v2 offset:4096
    ds_read_b128 v[148:151], v2 offset:5120
    ds_read_b128 v[152:155], v2 offset:20480
    ds_read_b128 v[156:159], v2 offset:21504
    s_waitcnt vmcnt(8)
    s_cbranch_vccz A2_NP01
    v_perm_b32 v14, v56, v24, s49
    v_perm_b32 v24, v56, v24, s48
    v_mov_b32 v56, v14
    v_perm_b32 v14, v57, v25, s49
    v_perm_b32 v25, v57, v25, s48
    v_mov_b32 v57, v14
    v_perm_b32 v14, v58, v26, s49
    v_perm_b32 v26, v58, v26, s48
    v_mov_b32 v58, v14
    v_perm_b32 v14, v59, v27, s49
    v_perm_b32 v27, v59, v27, s48
    v_mov_b32 v59, v14
    v_perm_b32 v14, v60, v28, s49
    v_perm_b32 v28, v60, v28, s48
    v_mov_b32 v60, v14
    v_perm_b32 v14, v61, v29, s49
    v_perm_b32 v29, v61, v29, s48
    v_mov_b32 v61, v14
    v_perm_b32 v14, v62, v30, s49
    v_perm_b32 v30, v62, v30, s48
    v_mov_b32 v62, v14
    v_perm_b32 v14, v63, v31, s49
    v_perm_b32 v31, v63, v31, s48
    v_mov_b32 v63, v14
A2_NP01:
    s_waitcnt lgkmcnt(4)
    v_mfma_f32_32x32x16_bf16 v[80:95], v[24:27], v[160:163], v[80:95]
    v_mfma_f32_32x32x16_bf16 v[112:127], v[56:59], v[168:171], v[112:127]
    v_mfma_f32_32x32x16_bf16 v[80:95], v[28:31], v[164:167], v[80:95]
    v_mfma_f32_32x32x16_bf16 v[112:127], v[60:63], v[172:175], v[112:127]
    ds_read_b128 v[160:163], v2 offset:6144
    ds_read_b128 v[164:167], v2 offset:7168
    ds_read_b128 v[168:171], v2 offset:22528
    ds_read_b128 v[172:175], v2 offset:23552
    s_waitcnt vmcnt(4)
    s_cbranch_vccz A2_NP02
    v_perm_b32 v14, v64, v32, s49
    v_perm_b32 v32, v64, v32, s48
    v_mov_b32 v64, v14
    v_perm_b32 v14, v65, v33, s49
    v_perm_b32 v33, v65, v33, s48
    v_mov_b32 v65, v14
    v_perm_b32 v14, v66, v34, s49
    v_perm_b32 v34, v66, v34, s48
    v_mov_b32 v66, v14
    v_perm_b32 v14, v67, v35, s49
    v_perm_b32 v35, v67, v35, s48
    v_mov_b32 v67, v14
    v_perm_b32 v14, v68, v36, s49
    v_perm_b32 v36, v68, v36, s48
    v_mov_b32 v68, v14
    v_perm_b32 v14, v69, v37, s49
    v_perm_b32 v37, v69, v37, s48
    v_mov_b32 v69, v14
    v_perm_b32 v14, v70, v38, s49
    v_perm_b32 v38, v70, v38, s48
    v_mov_b32 v70, v14
    v_perm_b32 v14, v71, v39, s49
    v_perm_b32 v39, v71, v39, s48
    v_mov_b32 v71, v14
A2_NP02:
    s_waitcnt lgkmcnt(4)
    v_mfma_f32_32x32x16_bf16 v[80:95], v[32:35], v[144:147], v[80:95]
    v_mfma_f32_32x32x16_bf16 v[112:127], v[64:67], v[152:155], v[112:127]
    v_mfma_f32_32x32x16_bf16 v[80:95], v[36:39], v[148:151], v[80:95]
    v_mfma_f32_32x32x16_bf16 v[112:127], v[68:71], v[156:159], v[112:127]
    s_waitcnt vmcnt(0)
    s_cbranch_vccz A2_NP03
    v_perm_b32 v14, v72, v40, s49
    v_perm_b32 v40, v72, v40, s48
    v_mov_b32 v72, v14
    v_perm_b32 v14, v73, v41, s49
    v_perm_b32 v41, v73, v41, s48
    v_mov_b32 v73, v14
    v_perm_b32 v14, v74, v42, s49
    v_perm_b32 v42, v74, v42, s48
    v_mov_b32 v74, v14
    v_perm_b32 v14, v75, v43, s49
    v_perm_b32 v43, v75, v43, s48
    v_mov_b32 v75, v14
    v_perm_b32 v14, v76, v44, s49
    v_perm_b32 v44, v76, v44, s48
    v_mov_b32 v76, v14
    v_perm_b32 v14, v77, v45, s49
    v_perm_b32 v45, v77, v45, s48
    v_mov_b32 v77, v14
    v_perm_b32 v14, v78, v46, s49
    v_perm_b32 v46, v78, v46, s48
    v_mov_b32 v78, v14
    v_perm_b32 v14, v79, v47, s49
    v_perm_b32 v47, v79, v47, s48
    v_mov_b32 v79, v14
A2_NP03:
    s_waitcnt lgkmcnt(0)
    v_mfma_f32_32x32x16_bf16 v[80:95], v[40:43], v[160:163], v[80:95]
    v_mfma_f32_32x32x16_bf16 v[112:127], v[72:75], v[168:171], v[112:127]
    v_mfma_f32_32x32x16_bf16 v[80:95], v[44:47], v[164:167], v[80:95]
    v_mfma_f32_32x32x16_bf16 v[112:127], v[76:79], v[172:175], v[112:127]
    s_mov_b64 vcc, 0
A2_HALF:
    ds_read_b128 v[144:147], v2 offset:8192
    ds_read_b128 v[148:151], v2 offset:9216
    ds_read_b128 v[152:155], v2 offset:24576
    ds_read_b128 v[156:159], v2 offset:25600
    ds_read_b128 v[160:163], v2 offset:10240
    ds_read_b128 v[164:167], v2 offset:11264
    ds_read_b128 v[168:171], v2 offset:26624
    ds_read_b128 v[172:175], v2 offset:27648
    s_waitcnt vmcnt(12)
    s_cbranch_vccz A2_NP10
    v_perm_b32 v14, v48, v16, s49
    v_perm_b32 v16, v48, v16, s48
    v_mov_b32 v48, v14
    v_perm_b32 v14, v49, v17, s49
    v_perm_b32 v17, v49, v17, s48
    v_mov_b32 v49, v14
    v_perm_b32 v14, v50, v18, s49
    v_perm_b32 v18, v50, v18, s48
    v_mov_b32 v50, v14
    v_perm_b32 v14, v51, v19, s49
    v_perm_b32 v19, v51, v19, s48
    v_mov_b32 v51, v14
    v_perm_b32 v14, v52, v20, s49
    v_perm_b32 v20, v52, v20, s48
    v_mov_b32 v52, v14
    v_perm_b32 v14, v53, v21, s49
    v_perm_b32 v21, v53, v21, s48
    v_mov_b32 v53, v14
    v_perm_b32 v14, v54, v22, s49
    v_perm_b32 v22, v54, v22, s48
    v_mov_b32 v54, v14
    v_perm_b32 v14, v55, v23, s49
    v_perm_b32 v23, v55, v23, s48
    v_mov_b32 v55, v14
A2_NP10:
    s_waitcnt lgkmcnt(4)
    v_mfma_f32_32x32x16_bf16 v[96:111], v[16:19], v[144:147], 0
    v_mfma_f32_32x32x16_bf16 v[128:143], v[48:51], v[152:155], 0
    v_mfma_f32_32x32x16_bf16 v[96:111], v[20:23], v[148:151], v[96:111]
    v_pk_fma_f32 v[176:177], s[46:47], v[112:113], v[80:81] op_sel_hi:[0,1,1] neg_lo:[1,0,0] neg_hi:[1,0,0]
    v_pk_fma_f32 v[178:179], s[46:47], v[114:115], v[82:83] op_sel_hi:[0,1,1] neg_lo:[1,0,0] neg_hi:[1,0,0]
    v_pk_fma_f32 v[180:181], s[46:47], v[80:81], v[112:113] op_sel_hi:[0,1,1]
    v_mfma_f32_32x32x16_bf16 v[128:143], v[52:55], v[156:159], v[128:143]
    v_pk_fma_f32 v[182:183], s[46:47], v[82:83], v[114:115] op_sel_hi:[0,1,1]
    v_cvt_pk_bf16_f32 v184, v176, v177
    v_cvt_pk_bf16_f32 v185, v178, v179
    ds_read_b128 v[144:147], v2 offset:12288
    ds_read_b128 v[148:151], v2 offset:13312
    ds_read_b128 v[152:155], v2 offset:28672
    ds_read_b128 v[156:159], v2 offset:29696
    s_waitcnt vmcnt(8)
    s_cbranch_vccz A2_NP11
    v_perm_b32 v14, v56, v24, s49
    v_perm_b32 v24, v56, v24, s48
    v_mov_b32 v56, v14
    v_perm_b32 v14, v57, v25, s49
    v_perm_b32 v25, v57, v25, s48
    v_mov_b32 v57, v14
    v_perm_b32 v14, v58, v26, s49
    v_perm_b32 v26, v58, v26, s48
    v_mov_b32 v58, v14
    v_perm_b32 v14, v59, v27, s49
    v_perm_b32 v27, v59, v27, s48
    v_mov_b32 v59, v14
    v_perm_b32 v14, v60, v28, s49
    v_perm_b32 v28, v60, v28, s48
    v_mov_b32 v60, v14
    v_perm_b32 v14, v61, v29, s49
    v_perm_b32 v29, v61, v29, s48
    v_mov_b32 v61, v14
    v_perm_b32 v14, v62, v30, s49
    v_perm_b32 v30, v62, v30, s48
    v_mov_b32 v62, v14
    v_perm_b32 v14, v63, v31, s49
    v_perm_b32 v31, v63, v31, s48
    v_mov_b32 v63, v14
A2_NP11:
    s_waitcnt lgkmcnt(4)
    v_mfma_f32_32x32x16_bf16 v[96:111], v[24:27], v[160:163], v[96:111]
    v_cvt_pk_bf16_f32 v186, v180, v181
    v_cvt_pk_bf16_f32 v187, v182, v183
    ds_write_b64 v10, v[184:185] offset:0
    v_mfma_f32_32x32x16_bf16 v[128:143], v[56:59], v[168:171], v[128:143]
    ds_write_b64 v10, v[186:187] offset:20992
    v_pk_fma_f32 v[188:189], s[46:47], v[116:117], v[84:85] op_sel_hi:[0,1,1] neg_lo:[1,0,0] neg_hi:[1,0,0]
    v_pk_fma_f32 v[190:191], s[46:47], v[118:119], v[86:87] op_sel_hi:[0,1,1] neg_lo:[1,0,0] neg_hi:[1,0,0]
    v_mfma_f32_32x32x16_bf16 v[96:111], v[28:31], v[164:167], v[96:111]
    v_pk_fma_f32 v[192:193], s[46:47], v[84:85], v[116:117] op_sel_hi:[0,1,1]
    v_pk_fma_f32 v[194:195], s[46:47], v[86:87], v[118:119] op_sel_hi:[0,1,1]
    v_cvt_pk_bf16_f32 v196, v188, v189
    v_mfma_f32_32x32x16_bf16 v[128:143], v[60:63], v[172:175], v[128:143]
    v_cvt_pk_bf16_f32 v197, v190, v191
    v_cvt_pk_bf16_f32 v198, v192, v193
    v_cvt_pk_bf16_f32 v199, v194, v195
    ds_read_b128 v[160:163], v2 offset:14336
    ds_read_b128 v[164:167], v2 offset:15360
    ds_read_b128 v[168:171], v2 offset:30720
    ds_read_b128 v[172:175], v2 offset:31744
    s_waitcnt vmcnt(4)
    s_cbranch_vccz A2_NP12
    v_perm_b32 v14, v64, v32, s49
    v_perm_b32 v32, v64, v32, s48
    v_mov_b32 v64, v14
    v_perm_b32 v14, v65, v33, s49
    v_perm_b32 v33, v65, v33, s48
    v_mov_b32 v65, v14
    v_perm_b32 v14, v66, v34, s49
    v_perm_b32 v34, v66, v34, s48
    v_mov_b32 v66, v14
    v_perm_b32 v14, v67, v35, s49
    v_perm_b32 v35, v67, v35, s48
    v_mov_b32 v67, v14
    v_perm_b32 v14, v68, v36, s49
    v_perm_b32 v36, v68, v36, s48
    v_mov_b32 v68, v14
    v_perm_b32 v14, v69, v37, s49
    v_perm_b32 v37, v69, v37, s48
    v_mov_b32 v69, v14
    v_perm_b32 v14, v70, v38, s49
    v_perm_b32 v38, v70, v38, s48
    v_mov_b32 v70, v14
    v_perm_b32 v14, v71, v39, s49
    v_perm_b32 v39, v71, v39, s48
    v_mov_b32 v71, v14
A2_NP12:
    s_waitcnt lgkmcnt(4)
    v_mfma_f32_32x32x16_bf16 v[96:111], v[32:35], v[144:147], v[96:111]
    ds_write_b64 v10, v[196:197] offset:16
    ds_write_b64 v10, v[198:199] offset:21008
    v_pk_fma_f32 v[176:177], s[46:47], v[120:121], v[88:89] op_sel_hi:[0,1,1] neg_lo:[1,0,0] neg_hi:[1,0,0]
    v_mfma_f32_32x32x16_bf16 v[128:143], v[64:67], v[152:155], v[128:143]
    v_pk_fma_f32 v[178:179], s[46:47], v[122:123], v[90:91] op_sel_hi:[0,1,1] neg_lo:[1,0,0] neg_hi:[1,0,0]
    v_pk_fma_f32 v[180:181], s[46:47], v[88:89], v[120:121] op_sel_hi:[0,1,1]
    v_pk_fma_f32 v[182:183], s[46:47], v[90:91], v[122:123] op_sel_hi:[0,1,1]
    v_mfma_f32_32x32x16_bf16 v[96:111], v[36:39], v[148:151], v[96:111]
    v_cvt_pk_bf16_f32 v184, v176, v177
    v_cvt_pk_bf16_f32 v185, v178, v179
    v_cvt_pk_bf16_f32 v186, v180, v181
    v_mfma_f32_32x32x16_bf16 v[128:143], v[68:71], v[156:159], v[128:143]
    v_cvt_pk_bf16_f32 v187, v182, v183
    ds_write_b64 v10, v[184:185] offset:32
    ds_write_b64 v10, v[186:187] offset:21024
    s_waitcnt vmcnt(0)
    s_cbranch_vccz A2_NP13
    v_perm_b32 v14, v72, v40, s49
    v_perm_b32 v40, v72, v40, s48
    v_mov_b32 v72, v14
    v_perm_b32 v14, v73, v41, s49
    v_perm_b32 v41, v73, v41, s48
    v_mov_b32 v73, v14
    v_perm_b32 v14, v74, v42, s49
    v_perm_b32 v42, v74, v42, s48
    v_mov_b32 v74, v14
    v_perm_b32 v14, v75, v43, s49
    v_perm_b32 v43, v75, v43, s48
    v_mov_b32 v75, v14
    v_perm_b32 v14, v76, v44, s49
    v_perm_b32 v44, v76, v44, s48
    v_mov_b32 v76, v14
    v_perm_b32 v14, v77, v45, s49
    v_perm_b32 v45, v77, v45, s48
    v_mov_b32 v77, v14
    v_perm_b32 v14, v78, v46, s49
    v_perm_b32 v46, v78, v46, s48
    v_mov_b32 v78, v14
    v_perm_b32 v14, v79, v47, s49
    v_perm_b32 v47, v79, v47, s48
    v_mov_b32 v79, v14
A2_NP13:
    s_waitcnt lgkmcnt(0)
    v_mfma_f32_32x32x16_bf16 v[96:111], v[40:43], v[160:163], v[96:111]
    v_pk_fma_f32 v[188:189], s[46:47], v[124:125], v[92:93] op_sel_hi:[0,1,1] neg_lo:[1,0,0] neg_hi:[1,0,0]
    v_pk_fma_f32 v[190:191], s[46:47], v[126:127], v[94:95] op_sel_hi:[0,1,1] neg_lo:[1,0,0] neg_hi:[1,0,0]
    v_pk_fma_f32 v[192:193], s[46:47], v[92:93], v[124:125] op_sel_hi:[0,1,1]
    v_mfma_f32_32x32x16_bf16 v[128:143], v[72:75], v[168:171], v[128:143]
    v_pk_fma_f32 v[194:195], s[46:47], v[94:95], v[126:127] op_sel_hi:[0,1,1]
    v_cvt_pk_bf16_f32 v196, v188, v189
    v_cvt_pk_bf16_f32 v197, v190, v191
    v_mfma_f32_32x32x16_bf16 v[96:111], v[44:47], v[164:167], v[96:111]
    v_cvt_pk_bf16_f32 v198, v192, v193
    v_cvt_pk_bf16_f32 v199, v194, v195
    ds_write_b64 v10, v[196:197] offset:48
    v_mfma_f32_32x32x16_bf16 v[128:143], v[76:79], v[172:175], v[128:143]
    ds_write_b64 v10, v[198:199] offset:21040
    s_nop 10
    v_pk_fma_f32 v[176:177], s[46:47], v[128:129], v[96:97] op_sel_hi:[0,1,1] neg_lo:[1,0,0] neg_hi:[1,0,0]
    v_pk_fma_f32 v[178:179], s[46:47], v[130:131], v[98:99] op_sel_hi:[0,1,1] neg_lo:[1,0,0] neg_hi:[1,0,0]
    v_pk_fma_f32 v[180:181], s[46:47], v[96:97], v[128:129] op_sel_hi:[0,1,1]
    v_pk_fma_f32 v[182:183], s[46:47], v[98:99], v[130:131] op_sel_hi:[0,1,1]
    v_cvt_pk_bf16_f32 v184, v176, v177
    v_cvt_pk_bf16_f32 v185, v178, v179
    v_cvt_pk_bf16_f32 v186, v180, v181
    v_cvt_pk_bf16_f32 v187, v182, v183
    ds_write_b64 v9, v[184:185] offset:10496
    ds_write_b64 v9, v[186:187] offset:31488
    v_pk_fma_f32 v[188:189], s[46:47], v[132:133], v[100:101] op_sel_hi:[0,1,1] neg_lo:[1,0,0] neg_hi:[1,0,0]
    v_pk_fma_f32 v[190:191], s[46:47], v[134:135], v[102:103] op_sel_hi:[0,1,1] neg_lo:[1,0,0] neg_hi:[1,0,0]
    v_pk_fma_f32 v[192:193], s[46:47], v[100:101], v[132:133] op_sel_hi:[0,1,1]
    v_pk_fma_f32 v[194:195], s[46:47], v[102:103], v[134:135] op_sel_hi:[0,1,1]
    v_cvt_pk_bf16_f32 v196, v188, v189
    v_cvt_pk_bf16_f32 v197, v190, v191
    v_cvt_pk_bf16_f32 v198, v192, v193
    v_cvt_pk_bf16_f32 v199, v194, v195
    ds_write_b64 v9, v[196:197] offset:10512
    ds_write_b64 v9, v[198:199] offset:31504
    v_pk_fma_f32 v[176:177], s[46:47], v[136:137], v[104:105] op_sel_hi:[0,1,1] neg_lo:[1,0,0] neg_hi:[1,0,0]
    v_pk_fma_f32 v[178:179], s[46:47], v[138:139], v[106:107] op_sel_hi:[0,1,1] neg_lo:[1,0,0] neg_hi:[1,0,0]
    v_pk_fma_f32 v[180:181], s[46:47], v[104:105], v[136:137] op_sel_hi:[0,1,1]
    v_pk_fma_f32 v[182:183], s[46:47], v[106:107], v[138:139] op_sel_hi:[0,1,1]
    v_cvt_pk_bf16_f32 v184, v176, v177
    v_cvt_pk_bf16_f32 v185, v178, v179
    v_cvt_pk_bf16_f32 v186, v180, v181
    v_cvt_pk_bf16_f32 v187, v182, v183
    ds_write_b64 v9, v[184:185] offset:10528
    ds_write_b64 v9, v[186:187] offset:31520
    v_pk_fma_f32 v[188:189], s[46:47], v[140:141], v[108:109] op_sel_hi:[0,1,1] neg_lo:[1,0,0] neg_hi:[1,0,0]
    v_pk_fma_f32 v[190:191], s[46:47], v[142:143], v[110:111] op_sel_hi:[0,1,1] neg_lo:[1,0,0] neg_hi:[1,0,0]
    v_pk_fma_f32 v[192:193], s[46:47], v[108:109], v[140:141] op_sel_hi:[0,1,1]
    v_pk_fma_f32 v[194:195], s[46:47], v[110:111], v[142:143] op_sel_hi:[0,1,1]
    v_cvt_pk_bf16_f32 v196, v188, v189
    v_cvt_pk_bf16_f32 v197, v190, v191
    v_cvt_pk_bf16_f32 v198, v192, v193
    v_cvt_pk_bf16_f32 v199, v194, v195
    ds_write_b64 v9, v[196:197] offset:10544
    ds_write_b64 v9, v[198:199] offset:31536
A2_OUT:
    s_waitcnt lgkmcnt(0)
    s_barrier
    ds_read2_b64 v[48:51], v238 offset1:1
    ds_read2_b64 v[52:55], v239 offset1:1
    ds_read2_b64 v[56:59], v240 offset1:1
    ds_read2_b64 v[60:63], v241 offset1:1
    ds_read2_b64 v[64:67], v242 offset1:1
    s_waitcnt lgkmcnt(4)
    buffer_store_dwordx4 v[48:51], v243, s[36:39], s56 offen nt
    s_waitcnt lgkmcnt(3)
    buffer_store_dwordx4 v[52:55], v244, s[36:39], s56 offen nt
    s_waitcnt lgkmcnt(2)
    buffer_store_dwordx4 v[56:59], v245, s[36:39], s56 offen nt
    s_waitcnt lgkmcnt(1)
    buffer_store_dwordx4 v[60:63], v246, s[36:39], s56 offen nt
    s_waitcnt lgkmcnt(0)
    buffer_store_dwordx4 v[64:67], v247, s[36:39], s56 offen nt
    s_endpgm
K_END:
    s_endpgm
.section .rodata,"a"
.p2align 6
.amdhsa_kernel concat_heads__spectral_fnet__sliding_local_dilated__prompt_kernel
  .amdhsa_next_free_vgpr 256
  .amdhsa_next_free_sgpr 82
  .amdhsa_accum_offset 256
  .amdhsa_group_segment_fixed_size 0
  .amdhsa_kernarg_size 88
  .amdhsa_user_sgpr_count 2
  .amdhsa_user_sgpr_kernarg_segment_ptr 1
  .amdhsa_system_sgpr_workgroup_id_x 1
.end_amdhsa_kernel
```
